```python
import torch

def _softmax(x, axis=-1):
    return torch.softmax(x, dim=axis)

def _gelu(x):
    return torch.nn.functional.gelu(x, approximate='tanh')

def _silu(x):
    return torch.nn.functional.silu(x)

def _sigmoid(x):
    return torch.sigmoid(x)

def _layernorm(x, axis=-1, eps=1e-05):
    m = x.mean(dim=axis, keepdim=True)
    v = x.var(dim=axis, keepdim=True, unbiased=False)
    return (x - m) / torch.sqrt(v + eps)

def _scatter_add(tgt, idx, src, axis=0):
    return tgt.clone().index_add_(axis, idx, src)

def _segment_sum(src, seg, n):
    out = torch.zeros((n,) + src.shape[1:], dtype=src.dtype)
    return out.index_add_(0, seg, src)

def _pad(x, pw):
    flat = tuple((v for pair in reversed(pw) for v in pair))
    return torch.nn.functional.pad(x, flat)
kernel_name = 'adaLN_cond__ssm_conv_h3__swiglu_ffn__prompt'

def setup_inputs():

    _w = lambda a: (lambda t: t.to(torch.bfloat16) if t.is_floating_point() else t)(torch.as_tensor(a))

    def _A_setup():
        B, S, D = (1, 2048, 448)
        ks = 4
        return {'q': _w((lambda *s: torch.randn(*s, dtype=torch.bfloat16) * 0.05)(B, S, D)), 'k': _w((lambda *s: torch.randn(*s, dtype=torch.bfloat16) * 1.6)(B, S, D)), 'v': _w((lambda *s: torch.randn(*s, dtype=torch.bfloat16) * 1.6)(B, S, D)), 'shift_k': _w((lambda *s: torch.randn(*s, dtype=torch.bfloat16) * 1.6)(D, ks) * 0.5), 'ssm_k': _w((lambda *s: torch.randn(*s, dtype=torch.bfloat16) * 1.6)(D, S) * (1.0 / S ** 0.5)), 'ssm_D': _w((lambda *s: torch.randn(*s, dtype=torch.bfloat16) * 1.6)(D))}
    _A_in = _A_setup()

    def _B_setup():
        B, S, D, F = (1, 2048, 448, 1792)
        return {'x': _w((lambda *s: torch.randn(*s, dtype=torch.bfloat16) * 0.05)(B, S, D)), 'w_gate': _w((lambda *s: torch.randn(*s, dtype=torch.bfloat16) * 0.1)(D, F)), 'w_up': _w((lambda *s: torch.randn(*s, dtype=torch.bfloat16) * 0.1)(D, F)), 'w_down': _w((lambda *s: torch.randn(*s, dtype=torch.bfloat16) * 0.1)(F, D))}
    _B_in = _B_setup()
    return {'A_q': _A_in['q'], 'A_k': _A_in['k'], 'A_v': _A_in['v'], 'A_shift_k': _A_in['shift_k'], 'A_ssm_k': _A_in['ssm_k'], 'A_ssm_D': _A_in['ssm_D'], 'B_x': _B_in['x'], 'B_w_gate': _B_in['w_gate'], 'B_w_up': _B_in['w_up'], 'B_w_down': _B_in['w_down'], 'c': _w((lambda *s: torch.randn(*s, dtype=torch.bfloat16) * 0.2)(1, 448) * 8.0), 'w_mod': _w((lambda *s: torch.randn(*s, dtype=torch.bfloat16) * 0.2)(448, 6 * 448) * 448 ** (-0.5) * 8.0)}

def reference(A_q, A_k, A_v, A_shift_k, A_ssm_k, A_ssm_D, B_x, B_w_gate, B_w_up, B_w_down, c, w_mod):

    def _A_ref(q, k, v, shift_k, ssm_k, ssm_D):
        B, S, D = q.shape
        ks = shift_k.shape[-1]
        k_pad = _pad(k, ((0, 0), (ks - 1, 0), (0, 0)))
        k_shift = torch.zeros_like(k)
        for t in range(ks):
            k_shift = k_shift + k_pad[:, t:t + S, :] * shift_k[:, ks - 1 - t][None, None, :]
        kv = k_shift * v
        L = 2 * S
        kv_pad = _pad(kv, ((0, 0), (0, S), (0, 0)))
        kf_pad = _pad(ssm_k, ((0, 0), (0, S)))
        kv_f = (lambda x, axes=(-2, -1): torch.fft.rfft2(x.float(), dim=axes))(kv_pad[:, None, :, :], axes=(1, 2))
        kf_f = (lambda x, axes=(-2, -1): torch.fft.rfft2(x.float(), dim=axes))(kf_pad[:, None, :], axes=(1, 2))
        kf_f = (lambda x, *d: x.permute(*d))(kf_f, 1, 2, 0)
        y_f = kv_f * kf_f[None, :, :, :]
        y = (lambda x, s, axes=(-2, -1): torch.fft.irfft2(x, s=s, dim=axes).to(torch.bfloat16))(y_f, (1, L), axes=(1, 2))[:, 0, :S, :]
        y = y + kv * ssm_D[None, None, :]
        return q * y

    def _B_ref(x, w_gate, w_up, w_down):
        g = _silu(x @ w_gate)
        u = x @ w_up
        return g * u @ w_down
    x = A_q
    mod = (_silu(c) @ w_mod).reshape(c.shape[0], 6, 1, -1)
    sa, ca, ga, sb, cb, gb = (mod[:, 0].clone(), mod[:, 1].clone(), mod[:, 2].clone(), mod[:, 3].clone(), mod[:, 4].clone(), mod[:, 5].clone())
    h = _layernorm(x, axis=-1) * (1 + ca) + sa
    x = x + ga * _A_ref(h, A_k, A_v, A_shift_k, A_ssm_k, A_ssm_D)
    h = _layernorm(x, axis=-1) * (1 + cb) + sb
    x = x + gb * _B_ref(h, B_w_gate, B_w_up, B_w_down)
    return x
```

```asm
; @launch grid=(256,1,1) block=(256,1,1) lds=163840
.amdgcn_target "amdgcn-amd-amdhsa--gfx950"
.text
.globl adaLN_cond__ssm_conv_h3__swiglu_ffn__prompt_kernel
.p2align 8
.type adaLN_cond__ssm_conv_h3__swiglu_ffn__prompt_kernel,@function
adaLN_cond__ssm_conv_h3__swiglu_ffn__prompt_kernel:
    s_cmp_ge_u32 s2, 256
    s_cbranch_scc1 L_end
    s_load_dwordx8 s[4:11], s[0:1], 0
    s_load_dwordx4 s[12:15], s[0:1], 32
    s_load_dwordx16 s[16:31], s[0:1], 56
    v_lshrrev_b32 v1, 6, v0
    v_and_b32 v8, 63, v0
    v_readfirstlane_b32 s32, v1
    v_lshlrev_b32 v2, 2, v8
    v_lshlrev_b32 v5, 4, v8
    s_and_b32 s33, s2, 3
    s_lshl_b32 s33, s33, 2
    s_bfe_u32 s92, s2, 0x20003
    s_add_u32 s33, s33, s92
    s_bfe_u32 s34, s2, 0x10002
    s_lshr_b32 s35, s2, 5
    s_lshl_b32 s37, s33, 1
    s_add_u32 s37, s37, s34
    s_mul_i32 s36, s37, 7
    s_add_u32 s36, s36, s35
    s_mul_i32 s38, s34, 7
    s_add_u32 s38, s38, s35
    s_cmp_eq_u32 s35, 7
    s_cselect_b32 s36, s37, s36
    s_lshl_b32 s37, s37, 3
    s_add_u32 s37, s37, s35
    s_lshl_b32 s100, s33, 6
    s_lshl_b32 s3, s34, 10
    s_add_u32 s100, s100, s3
    s_lshl_b32 s3, s35, 3
    s_add_u32 s100, s100, s3
    v_lshrrev_b32 v1, 4, v8
    v_and_b32 v9, 1, v1
    v_lshlrev_b32 v9, 3, v9
    v_and_b32 v10, 15, v8
    v_xor_b32 v9, v9, v10
    v_mul_u32_u24 v1, 3584, v1
    v_lshl_add_u32 v1, v9, 4, v1
    s_lshl_b32 s92, s38, 8
    v_add_u32 v6, s92, v1
    v_bfe_u32 v9, v8, 2, 2
    v_lshrrev_b32 v1, 5, v8
    v_lshl_add_u32 v1, v1, 3, v9
    v_lshlrev_b32 v1, 8, v1
    v_and_b32 v9, 1, v9
    s_lshr_b32 s92, s32, 1
    v_xor_b32 v9, s92, v9
    v_lshl_add_u32 v1, v9, 7, v1
    s_and_b32 s92, s32, 1
    s_lshl_b32 s92, s92, 6
    v_add_u32 v1, s92, v1
    v_bfe_u32 v9, v8, 4, 1
    v_lshl_add_u32 v1, v9, 5, v1
    v_and_b32 v9, 3, v8
    v_lshl_add_u32 v1, v9, 3, v1
    v_add_u32 v7, 65536, v1
    v_add_u32 v3, 114688, v1
    v_and_b32 v4, 1, v8
    v_sub_u32 v4, 0, v4
    s_cmp_eq_u32 s35, 7
    s_cbranch_scc1 L_extra
    s_lshr_b32 s92, s36, 5
    s_lshl_b32 s92, s92, 7
    s_and_b32 s93, s36, 31
    s_lshl_b32 s93, s93, 6
    v_and_b32 v1, 7, v0
    v_lshlrev_b32 v1, 2, v1
    v_lshrrev_b32 v8, 6, v0
    v_lshl_add_u32 v1, v8, 5, v1
    v_add_u32 v120, s92, v1
    v_bfe_u32 v8, v0, 3, 3
    v_lshl_add_u32 v121, v8, 3, s93
    v_mul_u32_u24 v122, 896, v121
    v_add_u32 v122, v122, v120
    v_subrev_u32 v123, 2688, v122
    v_lshlrev_b32 v124, 2, v120
    v_mul_u32_u24 v125, 2112, v120
    v_lshlrev_b32 v8, 1, v121
    v_sub_u32 v125, v125, v8
    v_add_u32 v125, 4080, v125
    v_add_u32 v126, 4224, v125
    s_movk_i32 s94, 4480
    s_lshr_b32 s95, s32, 1
    s_lshl_b32 s96, s36, 1
    s_add_u32 s96, s96, s95
    s_lshl_b32 s96, s96, 12
    v_and_b32 v8, 127, v0
    v_lshlrev_b32 v8, 4, v8
    v_add_u32 v127, s96, v8
    s_waitcnt lgkmcnt(0)
    s_add_u32 s40, s30, 4718592
    s_addc_u32 s41, s31, 0
    s_mov_b32 s42, 38912
    s_mov_b32 s43, 0x00020000
    s_lshl_b32 s3, s33, 10
    s_add_u32 s3, s3, 22528
    v_add_u32 v246, s3, v5
    s_lshl_b32 s3, s37, 2
    s_add_u32 s3, s3, 22528
    v_lshl_add_u32 v245, v2, 8, s3
    s_cmp_lg_u32 s32, 0
    s_cbranch_scc1 Lsn_1
    buffer_load_dwordx4 v[240:243], v246, s[40:43], 0 offen sc1
    s_mov_b64 exec, 0xffff
    buffer_load_dword v244, v245, s[40:43], 0 offen sc1
    s_mov_b64 exec, -1
Lsn_1:
    s_mov_b32 s44, s6
    s_mov_b32 s45, s7
    s_mov_b32 s46, 1835008
    s_mov_b32 s47, 0x00020000
    s_mov_b32 s48, s8
    s_mov_b32 s49, s9
    s_mov_b32 s50, 1835008
    s_mov_b32 s51, 0x00020000
    s_mov_b32 s52, s10
    s_mov_b32 s53, s11
    s_mov_b32 s54, 3584
    s_mov_b32 s55, 0x00020000
    s_mov_b32 s56, s12
    s_mov_b32 s57, s13
    s_mov_b32 s58, 1835008
    s_mov_b32 s59, 0x00020000
    buffer_load_dwordx4 v[28:31], v124, s[52:55], 0 offen
    buffer_load_dword v9, v123, s[44:47], 0 offen offset:0
    buffer_load_dword v10, v123, s[44:47], 0 offen offset:896
    buffer_load_dword v11, v123, s[44:47], 0 offen offset:1792
    buffer_load_dword v12, v122, s[44:47], 0 offen offset:0
    buffer_load_dword v13, v122, s[44:47], 0 offen offset:896
    buffer_load_dword v14, v122, s[44:47], 0 offen offset:1792
    buffer_load_dword v15, v122, s[44:47], 0 offen offset:2688
    buffer_load_dword v16, v122, s[44:47], 0 offen offset:3584
    buffer_load_dword v17, v122, s[44:47], s94 offen offset:0
    buffer_load_dword v18, v122, s[44:47], s94 offen offset:896
    buffer_load_dword v19, v122, s[44:47], s94 offen offset:1792
    buffer_load_dword v20, v122, s[48:51], 0 offen offset:0
    buffer_load_dword v21, v122, s[48:51], 0 offen offset:896
    buffer_load_dword v22, v122, s[48:51], 0 offen offset:1792
    buffer_load_dword v23, v122, s[48:51], 0 offen offset:2688
    buffer_load_dword v24, v122, s[48:51], 0 offen offset:3584
    buffer_load_dword v25, v122, s[48:51], s94 offen offset:0
    buffer_load_dword v26, v122, s[48:51], s94 offen offset:896
    buffer_load_dword v27, v122, s[48:51], s94 offen offset:1792
    buffer_load_dwordx4 v[128:131], v127, s[56:59], 0 offen offset:0
    buffer_load_dwordx4 v[132:135], v127, s[56:59], 0 offen offset:4
    buffer_load_dwordx4 v[136:139], v127, s[56:59], 0 offen offset:8
    buffer_load_dwordx4 v[140:143], v127, s[56:59], 0 offen offset:2048
    buffer_load_dwordx4 v[144:147], v127, s[56:59], 0 offen offset:2052
    buffer_load_dwordx4 v[148:151], v127, s[56:59], 0 offen offset:2056
    v_cmp_gt_u32 vcc, 224, v2
    s_mov_b64 s[6:7], vcc
    s_lshl_b32 s10, s33, 8
    s_and_b32 s3, s37, 15
    s_lshl_b32 s3, s3, 2
    s_add_u32 s10, s10, s3
    s_add_u32 s10, s10, 16384
    s_add_u32 s11, s34, 1
    s_lshl_b32 s8, s32, 10
    s_mul_i32 s9, s32, 14336
    s_lshl_b32 s93, s32, 1
    s_add_u32 s92, s100, s93
    s_mul_i32 s93, s92, 896
    v_add_u32 v236, s93, v5
    s_mov_b32 s52, s4
    s_mov_b32 s53, s5
    s_mov_b32 s54, 1835008
    s_mov_b32 s55, 0x00020000
    buffer_load_dwordx4 v[208:211], v236, s[52:55], 0 offen offset:0
    buffer_load_dwordx4 v[212:215], v236, s[52:55], 0 offen offset:896
    s_lshl_b32 s3, s37, 2
    v_lshl_add_u32 v8, v2, 8, s3
    v_mov_b32 v247, s10
    s_lshr_b32 s3, s37, 3
    s_lshl_b32 s3, s3, 2
    s_add_u32 s3, s3, 20480
    v_lshl_add_u32 v252, v2, 5, s3
    s_cmp_lg_u32 s32, 0
    s_cbranch_scc1 Lzf_2
    v_mov_b32 v1, 0
    s_mov_b64 exec, 0xffff
    buffer_store_dword v1, v8, s[40:43], 0 offen sc1
    s_mov_b64 exec, 1
    buffer_store_dword v1, v247, s[40:43], 0 offen offset:0 sc1
    buffer_store_dword v1, v247, s[40:43], 0 offen offset:128 sc1
    buffer_store_dword v1, v247, s[40:43], 0 offen offset:192 sc1
    s_cmp_lg_u32 s35, 0
    s_cbranch_scc1 Lzf_3
    buffer_store_dword v1, v247, s[40:43], 0 offen offset:28 sc1
    buffer_store_dword v1, v247, s[40:43], 0 offen offset:156 sc1
    buffer_store_dword v1, v247, s[40:43], 0 offen offset:220 sc1
    s_mov_b64 exec, 0xffff
    buffer_store_dword v1, v8, s[40:43], 0 offen offset:28 sc1
    buffer_store_dword v1, v252, s[40:43], 0 offen sc1
Lzf_3:
    s_mov_b64 exec, -1
Lzf_2:
    s_add_u32 s44, s30, 0
    s_addc_u32 s45, s31, 0
    s_mov_b32 s46, 1892352
    s_mov_b32 s47, 0x00020000
    s_lshl_b32 s95, s36, 2
    s_load_dword s96, s[14:15], s95
    s_waitcnt vmcnt(16)
    v_lshlrev_b32 v70, 16, v28
    v_lshlrev_b32 v71, 16, v30
    v_and_b32 v72, 0xffff0000, v28
    v_and_b32 v73, 0xffff0000, v30
    v_lshlrev_b32 v74, 16, v29
    v_lshlrev_b32 v75, 16, v31
    v_and_b32 v76, 0xffff0000, v29
    v_and_b32 v77, 0xffff0000, v31
    v_lshlrev_b32 v32, 16, v9
    v_and_b32 v33, 0xffff0000, v9
    v_lshlrev_b32 v34, 16, v10
    v_and_b32 v35, 0xffff0000, v10
    v_lshlrev_b32 v36, 16, v11
    v_and_b32 v37, 0xffff0000, v11
    v_lshlrev_b32 v38, 16, v12
    v_and_b32 v39, 0xffff0000, v12
    v_lshlrev_b32 v40, 16, v13
    v_and_b32 v41, 0xffff0000, v13
    v_lshlrev_b32 v42, 16, v14
    v_and_b32 v43, 0xffff0000, v14
    v_lshlrev_b32 v44, 16, v15
    v_and_b32 v45, 0xffff0000, v15
    v_lshlrev_b32 v46, 16, v16
    v_and_b32 v47, 0xffff0000, v16
    v_lshlrev_b32 v48, 16, v17
    v_and_b32 v49, 0xffff0000, v17
    v_lshlrev_b32 v50, 16, v18
    v_and_b32 v51, 0xffff0000, v18
    v_lshlrev_b32 v52, 16, v19
    v_and_b32 v53, 0xffff0000, v19
    v_pk_mul_f32 v[78:79], v[32:33], v[76:77]
    v_pk_mul_f32 v[80:81], v[34:35], v[76:77]
    v_pk_mul_f32 v[82:83], v[36:37], v[76:77]
    v_pk_mul_f32 v[84:85], v[38:39], v[76:77]
    v_pk_mul_f32 v[86:87], v[40:41], v[76:77]
    v_pk_mul_f32 v[88:89], v[42:43], v[76:77]
    v_pk_mul_f32 v[90:91], v[44:45], v[76:77]
    v_pk_mul_f32 v[92:93], v[46:47], v[76:77]
    v_cvt_pk_bf16_f32 v110, v78, v79
    v_cvt_pk_bf16_f32 v111, v80, v81
    v_cvt_pk_bf16_f32 v112, v82, v83
    v_cvt_pk_bf16_f32 v113, v84, v85
    v_cvt_pk_bf16_f32 v114, v86, v87
    v_cvt_pk_bf16_f32 v115, v88, v89
    v_cvt_pk_bf16_f32 v116, v90, v91
    v_cvt_pk_bf16_f32 v117, v92, v93
    v_lshlrev_b32 v78, 16, v110
    v_and_b32 v79, 0xffff0000, v110
    v_lshlrev_b32 v80, 16, v111
    v_and_b32 v81, 0xffff0000, v111
    v_lshlrev_b32 v82, 16, v112
    v_and_b32 v83, 0xffff0000, v112
    v_lshlrev_b32 v84, 16, v113
    v_and_b32 v85, 0xffff0000, v113
    v_lshlrev_b32 v86, 16, v114
    v_and_b32 v87, 0xffff0000, v114
    v_lshlrev_b32 v88, 16, v115
    v_and_b32 v89, 0xffff0000, v115
    v_lshlrev_b32 v90, 16, v116
    v_and_b32 v91, 0xffff0000, v116
    v_lshlrev_b32 v92, 16, v117
    v_and_b32 v93, 0xffff0000, v117
    v_pk_mul_f32 v[94:95], v[34:35], v[74:75]
    v_pk_mul_f32 v[96:97], v[36:37], v[74:75]
    v_pk_mul_f32 v[98:99], v[38:39], v[74:75]
    v_pk_mul_f32 v[100:101], v[40:41], v[74:75]
    v_pk_mul_f32 v[102:103], v[42:43], v[74:75]
    v_pk_mul_f32 v[104:105], v[44:45], v[74:75]
    v_pk_mul_f32 v[106:107], v[46:47], v[74:75]
    v_pk_mul_f32 v[108:109], v[48:49], v[74:75]
    v_cvt_pk_bf16_f32 v110, v94, v95
    v_cvt_pk_bf16_f32 v111, v96, v97
    v_cvt_pk_bf16_f32 v112, v98, v99
    v_cvt_pk_bf16_f32 v113, v100, v101
    v_cvt_pk_bf16_f32 v114, v102, v103
    v_cvt_pk_bf16_f32 v115, v104, v105
    v_cvt_pk_bf16_f32 v116, v106, v107
    v_cvt_pk_bf16_f32 v117, v108, v109
    v_lshlrev_b32 v94, 16, v110
    v_and_b32 v95, 0xffff0000, v110
    v_lshlrev_b32 v96, 16, v111
    v_and_b32 v97, 0xffff0000, v111
    v_lshlrev_b32 v98, 16, v112
    v_and_b32 v99, 0xffff0000, v112
    v_lshlrev_b32 v100, 16, v113
    v_and_b32 v101, 0xffff0000, v113
    v_lshlrev_b32 v102, 16, v114
    v_and_b32 v103, 0xffff0000, v114
    v_lshlrev_b32 v104, 16, v115
    v_and_b32 v105, 0xffff0000, v115
    v_lshlrev_b32 v106, 16, v116
    v_and_b32 v107, 0xffff0000, v116
    v_lshlrev_b32 v108, 16, v117
    v_and_b32 v109, 0xffff0000, v117
    v_pk_add_f32 v[78:79], v[78:79], v[94:95]
    v_pk_add_f32 v[80:81], v[80:81], v[96:97]
    v_pk_add_f32 v[82:83], v[82:83], v[98:99]
    v_pk_add_f32 v[84:85], v[84:85], v[100:101]
    v_pk_add_f32 v[86:87], v[86:87], v[102:103]
    v_pk_add_f32 v[88:89], v[88:89], v[104:105]
    v_pk_add_f32 v[90:91], v[90:91], v[106:107]
    v_pk_add_f32 v[92:93], v[92:93], v[108:109]
    v_cvt_pk_bf16_f32 v110, v78, v79
    v_cvt_pk_bf16_f32 v111, v80, v81
    v_cvt_pk_bf16_f32 v112, v82, v83
    v_cvt_pk_bf16_f32 v113, v84, v85
    v_cvt_pk_bf16_f32 v114, v86, v87
    v_cvt_pk_bf16_f32 v115, v88, v89
    v_cvt_pk_bf16_f32 v116, v90, v91
    v_cvt_pk_bf16_f32 v117, v92, v93
    v_lshlrev_b32 v78, 16, v110
    v_and_b32 v79, 0xffff0000, v110
    v_lshlrev_b32 v80, 16, v111
    v_and_b32 v81, 0xffff0000, v111
    v_lshlrev_b32 v82, 16, v112
    v_and_b32 v83, 0xffff0000, v112
    v_lshlrev_b32 v84, 16, v113
    v_and_b32 v85, 0xffff0000, v113
    v_lshlrev_b32 v86, 16, v114
    v_and_b32 v87, 0xffff0000, v114
    v_lshlrev_b32 v88, 16, v115
    v_and_b32 v89, 0xffff0000, v115
    v_lshlrev_b32 v90, 16, v116
    v_and_b32 v91, 0xffff0000, v116
    v_lshlrev_b32 v92, 16, v117
    v_and_b32 v93, 0xffff0000, v117
    v_pk_mul_f32 v[94:95], v[36:37], v[72:73]
    v_pk_mul_f32 v[96:97], v[38:39], v[72:73]
    v_pk_mul_f32 v[98:99], v[40:41], v[72:73]
    v_pk_mul_f32 v[100:101], v[42:43], v[72:73]
    v_pk_mul_f32 v[102:103], v[44:45], v[72:73]
    v_pk_mul_f32 v[104:105], v[46:47], v[72:73]
    v_pk_mul_f32 v[106:107], v[48:49], v[72:73]
    v_pk_mul_f32 v[108:109], v[50:51], v[72:73]
    v_cvt_pk_bf16_f32 v110, v94, v95
    v_cvt_pk_bf16_f32 v111, v96, v97
    v_cvt_pk_bf16_f32 v112, v98, v99
    v_cvt_pk_bf16_f32 v113, v100, v101
    v_cvt_pk_bf16_f32 v114, v102, v103
    v_cvt_pk_bf16_f32 v115, v104, v105
    v_cvt_pk_bf16_f32 v116, v106, v107
    v_cvt_pk_bf16_f32 v117, v108, v109
    v_lshlrev_b32 v94, 16, v110
    v_and_b32 v95, 0xffff0000, v110
    v_lshlrev_b32 v96, 16, v111
    v_and_b32 v97, 0xffff0000, v111
    v_lshlrev_b32 v98, 16, v112
    v_and_b32 v99, 0xffff0000, v112
    v_lshlrev_b32 v100, 16, v113
    v_and_b32 v101, 0xffff0000, v113
    v_lshlrev_b32 v102, 16, v114
    v_and_b32 v103, 0xffff0000, v114
    v_lshlrev_b32 v104, 16, v115
    v_and_b32 v105, 0xffff0000, v115
    v_lshlrev_b32 v106, 16, v116
    v_and_b32 v107, 0xffff0000, v116
    v_lshlrev_b32 v108, 16, v117
    v_and_b32 v109, 0xffff0000, v117
    v_pk_add_f32 v[78:79], v[78:79], v[94:95]
    v_pk_add_f32 v[80:81], v[80:81], v[96:97]
    v_pk_add_f32 v[82:83], v[82:83], v[98:99]
    v_pk_add_f32 v[84:85], v[84:85], v[100:101]
    v_pk_add_f32 v[86:87], v[86:87], v[102:103]
    v_pk_add_f32 v[88:89], v[88:89], v[104:105]
    v_pk_add_f32 v[90:91], v[90:91], v[106:107]
    v_pk_add_f32 v[92:93], v[92:93], v[108:109]
    v_cvt_pk_bf16_f32 v110, v78, v79
    v_cvt_pk_bf16_f32 v111, v80, v81
    v_cvt_pk_bf16_f32 v112, v82, v83
    v_cvt_pk_bf16_f32 v113, v84, v85
    v_cvt_pk_bf16_f32 v114, v86, v87
    v_cvt_pk_bf16_f32 v115, v88, v89
    v_cvt_pk_bf16_f32 v116, v90, v91
    v_cvt_pk_bf16_f32 v117, v92, v93
    v_lshlrev_b32 v78, 16, v110
    v_and_b32 v79, 0xffff0000, v110
    v_lshlrev_b32 v80, 16, v111
    v_and_b32 v81, 0xffff0000, v111
    v_lshlrev_b32 v82, 16, v112
    v_and_b32 v83, 0xffff0000, v112
    v_lshlrev_b32 v84, 16, v113
    v_and_b32 v85, 0xffff0000, v113
    v_lshlrev_b32 v86, 16, v114
    v_and_b32 v87, 0xffff0000, v114
    v_lshlrev_b32 v88, 16, v115
    v_and_b32 v89, 0xffff0000, v115
    v_lshlrev_b32 v90, 16, v116
    v_and_b32 v91, 0xffff0000, v116
    v_lshlrev_b32 v92, 16, v117
    v_and_b32 v93, 0xffff0000, v117
    v_pk_mul_f32 v[94:95], v[38:39], v[70:71]
    v_pk_mul_f32 v[96:97], v[40:41], v[70:71]
    v_pk_mul_f32 v[98:99], v[42:43], v[70:71]
    v_pk_mul_f32 v[100:101], v[44:45], v[70:71]
    v_pk_mul_f32 v[102:103], v[46:47], v[70:71]
    v_pk_mul_f32 v[104:105], v[48:49], v[70:71]
    v_pk_mul_f32 v[106:107], v[50:51], v[70:71]
    v_pk_mul_f32 v[108:109], v[52:53], v[70:71]
    v_cvt_pk_bf16_f32 v110, v94, v95
    v_cvt_pk_bf16_f32 v111, v96, v97
    v_cvt_pk_bf16_f32 v112, v98, v99
    v_cvt_pk_bf16_f32 v113, v100, v101
    v_cvt_pk_bf16_f32 v114, v102, v103
    v_cvt_pk_bf16_f32 v115, v104, v105
    v_cvt_pk_bf16_f32 v116, v106, v107
    v_cvt_pk_bf16_f32 v117, v108, v109
    v_lshlrev_b32 v94, 16, v110
    v_and_b32 v95, 0xffff0000, v110
    v_lshlrev_b32 v96, 16, v111
    v_and_b32 v97, 0xffff0000, v111
    v_lshlrev_b32 v98, 16, v112
    v_and_b32 v99, 0xffff0000, v112
    v_lshlrev_b32 v100, 16, v113
    v_and_b32 v101, 0xffff0000, v113
    v_lshlrev_b32 v102, 16, v114
    v_and_b32 v103, 0xffff0000, v114
    v_lshlrev_b32 v104, 16, v115
    v_and_b32 v105, 0xffff0000, v115
    v_lshlrev_b32 v106, 16, v116
    v_and_b32 v107, 0xffff0000, v116
    v_lshlrev_b32 v108, 16, v117
    v_and_b32 v109, 0xffff0000, v117
    v_pk_add_f32 v[78:79], v[78:79], v[94:95]
    v_pk_add_f32 v[80:81], v[80:81], v[96:97]
    v_pk_add_f32 v[82:83], v[82:83], v[98:99]
    v_pk_add_f32 v[84:85], v[84:85], v[100:101]
    v_pk_add_f32 v[86:87], v[86:87], v[102:103]
    v_pk_add_f32 v[88:89], v[88:89], v[104:105]
    v_pk_add_f32 v[90:91], v[90:91], v[106:107]
    v_pk_add_f32 v[92:93], v[92:93], v[108:109]
    v_cvt_pk_bf16_f32 v110, v78, v79
    v_cvt_pk_bf16_f32 v111, v80, v81
    v_cvt_pk_bf16_f32 v112, v82, v83
    v_cvt_pk_bf16_f32 v113, v84, v85
    v_cvt_pk_bf16_f32 v114, v86, v87
    v_cvt_pk_bf16_f32 v115, v88, v89
    v_cvt_pk_bf16_f32 v116, v90, v91
    v_cvt_pk_bf16_f32 v117, v92, v93
    v_lshlrev_b32 v78, 16, v110
    v_and_b32 v79, 0xffff0000, v110
    v_lshlrev_b32 v80, 16, v111
    v_and_b32 v81, 0xffff0000, v111
    v_lshlrev_b32 v82, 16, v112
    v_and_b32 v83, 0xffff0000, v112
    v_lshlrev_b32 v84, 16, v113
    v_and_b32 v85, 0xffff0000, v113
    v_lshlrev_b32 v86, 16, v114
    v_and_b32 v87, 0xffff0000, v114
    v_lshlrev_b32 v88, 16, v115
    v_and_b32 v89, 0xffff0000, v115
    v_lshlrev_b32 v90, 16, v116
    v_and_b32 v91, 0xffff0000, v116
    v_lshlrev_b32 v92, 16, v117
    v_and_b32 v93, 0xffff0000, v117
    s_waitcnt vmcnt(8)
    v_lshlrev_b32 v54, 16, v20
    v_and_b32 v55, 0xffff0000, v20
    v_lshlrev_b32 v56, 16, v21
    v_and_b32 v57, 0xffff0000, v21
    v_lshlrev_b32 v58, 16, v22
    v_and_b32 v59, 0xffff0000, v22
    v_lshlrev_b32 v60, 16, v23
    v_and_b32 v61, 0xffff0000, v23
    v_lshlrev_b32 v62, 16, v24
    v_and_b32 v63, 0xffff0000, v24
    v_lshlrev_b32 v64, 16, v25
    v_and_b32 v65, 0xffff0000, v25
    v_lshlrev_b32 v66, 16, v26
    v_and_b32 v67, 0xffff0000, v26
    v_lshlrev_b32 v68, 16, v27
    v_and_b32 v69, 0xffff0000, v27
    v_pk_mul_f32 v[78:79], v[78:79], v[54:55]
    v_pk_mul_f32 v[80:81], v[80:81], v[56:57]
    v_pk_mul_f32 v[82:83], v[82:83], v[58:59]
    v_pk_mul_f32 v[84:85], v[84:85], v[60:61]
    v_pk_mul_f32 v[86:87], v[86:87], v[62:63]
    v_pk_mul_f32 v[88:89], v[88:89], v[64:65]
    v_pk_mul_f32 v[90:91], v[90:91], v[66:67]
    v_pk_mul_f32 v[92:93], v[92:93], v[68:69]
    v_cvt_pk_bf16_f32 v152, v92, v90
    v_cvt_pk_bf16_f32 v153, v88, v86
    v_cvt_pk_bf16_f32 v154, v84, v82
    v_cvt_pk_bf16_f32 v155, v80, v78
    v_cvt_pk_bf16_f32 v156, v93, v91
    v_cvt_pk_bf16_f32 v157, v89, v87
    v_cvt_pk_bf16_f32 v158, v85, v83
    v_cvt_pk_bf16_f32 v159, v81, v79
    buffer_store_dwordx4 v[152:155], v125, s[44:47], 0 offen sc1
    buffer_store_dwordx4 v[156:159], v126, s[44:47], 0 offen sc1
    s_mov_b32 s52, s16
    s_mov_b32 s53, s17
    s_mov_b32 s54, 1605632
    s_mov_b32 s55, 0x00020000
    s_mov_b32 s56, s18
    s_mov_b32 s57, s19
    s_mov_b32 s58, 1605632
    s_mov_b32 s59, 0x00020000
    s_lshr_b32 s92, s32, 1
    s_lshl_b32 s93, s36, 1
    s_add_u32 s93, s93, s92
    s_mul_i32 s94, s92, 21248
    v_and_b32 v1, 127, v0
    v_lshlrev_b32 v9, 4, v1
    s_mul_i32 s3, s93, 4224
    v_add_u32 v10, s3, v9
    v_add_u32 v9, s94, v9
    s_and_b32 s95, s32, 1
    v_mov_b32 v64, 0
    v_mov_b32 v65, 0
    v_mov_b32 v66, 0
    v_mov_b32 v67, 0
    v_cmp_gt_u32 vcc, 32, v1
    s_and_saveexec_b64 s[98:99], vcc
    ds_write_b128 v9, v[64:67] offset:20736
    s_mov_b64 exec, s[98:99]
    v_and_b32 v11, 15, v0
    v_bfe_u32 v12, v0, 4, 2
    v_add_u32 v13, 1, v11
    v_and_b32 v14, 3, v13
    v_mul_u32_u24 v14, 4160, v14
    v_lshrrev_b32 v13, 2, v13
    v_lshl_add_u32 v14, v13, 3, v14
    v_lshl_add_u32 v14, v12, 4, v14
    s_lshl_b32 s97, s95, 6
    s_add_u32 s97, s97, s94
    v_add_u32 v14, s97, v14
    v_lshlrev_b32 v15, 5, v11
    v_lshlrev_b32 v16, 4, v12
    v_sub_u32 v16, v16, v15
    s_add_u32 s97, s97, 17120
    v_add_u32 v16, s97, v16
    v_lshlrev_b32 v17, 3, v12
    v_add_u32 v17, v17, v15
    s_lshl_b32 s97, s95, 10
    s_sub_u32 s97, s94, s97
    s_add_u32 s97, s97, 17144
    v_sub_u32 v18, s97, v17
    v_and_b32 v19, 1, v12
    v_lshlrev_b32 v19, 2, v19
    v_lshrrev_b32 v20, 2, v11
    v_add_u32 v19, v19, v20
    v_mul_u32_u24 v19, 448, v19
    v_add_u32 v19, s93, v19
    v_lshlrev_b32 v19, 7, v19
    v_and_b32 v20, 3, v11
    v_lshl_add_u32 v19, v20, 5, v19
    v_lshrrev_b32 v20, 1, v12
    v_lshl_add_u32 v19, v20, 4, v19
    s_lshl_b32 s97, s32, 12
    s_add_u32 s97, s97, 42496
    v_add_u32 v20, s97, v5
    s_and_b32 s97, s32, 2
    s_lshl_b32 s97, s97, 12
    s_lshl_b32 s3, s95, 11
    s_add_u32 s97, s97, s3
    s_add_u32 s97, s97, 42496
    v_add_u32 v21, s97, v5
    s_mul_i32 s3, s95, 458752
    v_add_u32 v19, s3, v19
    s_add_u32 s48, s30, 2097152
    s_addc_u32 s49, s31, 0
    s_mov_b32 s50, 1835008
    s_mov_b32 s51, 0x00020000
    s_waitcnt vmcnt(4)
    v_alignbit_b32 v68, v132, v128, 16
    v_alignbit_b32 v69, v133, v129, 16
    v_alignbit_b32 v70, v134, v130, 16
    v_alignbit_b32 v71, v135, v131, 16
    v_alignbit_b32 v72, v136, v132, 16
    v_alignbit_b32 v73, v137, v133, 16
    v_alignbit_b32 v74, v138, v134, 16
    v_alignbit_b32 v75, v139, v135, 16
    ds_write_b128 v9, v[128:131] offset:32
    ds_write_b128 v9, v[68:71] offset:4192
    ds_write_b128 v9, v[132:135] offset:8352
    ds_write_b128 v9, v[72:75] offset:12512
    v_cmp_eq_u32 vcc, 0, v1
    s_and_saveexec_b64 s[98:99], vcc
    v_mov_b32 v84, 0
    v_mov_b32 v88, 0
    v_mov_b32 v85, 0
    v_mov_b32 v89, 0
    v_mov_b32 v86, 0
    v_mov_b32 v90, 0
    v_mov_b32 v92, 0
    v_mov_b32 v93, 0
    v_lshlrev_b32 v87, 16, v128
    v_mov_b32 v91, v128
    v_lshlrev_b32 v94, 16, v128
    v_mov_b32 v95, v68
    ds_write_b128 v9, v[64:67] offset:0
    ds_write_b128 v9, v[64:67] offset:4160
    ds_write_b128 v9, v[64:67] offset:8320
    ds_write_b128 v9, v[64:67] offset:12480
    ds_write_b128 v9, v[64:67] offset:16
    ds_write_b128 v9, v[84:87] offset:4176
    ds_write_b128 v9, v[88:91] offset:8336
    ds_write_b128 v9, v[92:95] offset:12496
    s_mov_b64 exec, s[98:99]
    v_alignbit_b32 v76, v144, v140, 16
    v_alignbit_b32 v77, v145, v141, 16
    v_alignbit_b32 v78, v146, v142, 16
    v_alignbit_b32 v79, v147, v143, 16
    v_alignbit_b32 v80, v148, v144, 16
    v_alignbit_b32 v81, v149, v145, 16
    v_alignbit_b32 v82, v150, v146, 16
    v_alignbit_b32 v83, v151, v147, 16
    ds_write_b128 v9, v[140:143] offset:2080
    ds_write_b128 v9, v[76:79] offset:6240
    ds_write_b128 v9, v[144:147] offset:10400
    ds_write_b128 v9, v[80:83] offset:14560
    s_waitcnt vmcnt(0) lgkmcnt(0)
    s_barrier
    s_cmp_lg_u32 s32, 0
    s_cbranch_scc1 Lar_4
    s_mov_b64 exec, 0xffff
    v_add_u32 v244, 1, v244
    buffer_store_dword v244, v245, s[40:43], 0 offen sc1
    s_mov_b32 s44, s28
    s_mov_b32 s45, s29
    s_mov_b32 s46, 256
    s_mov_b32 s47, 0x00020000
    s_mov_b64 exec, 1
    v_mov_b32 v1, 1
    v_mov_b32 v8, s37
    buffer_store_byte v1, v8, s[44:47], 0 offen sc1
    s_mov_b64 exec, -1
Lar_4:
    s_add_u32 m0, s8, 65536
    s_add_u32 s39, s9, 0
    buffer_load_dwordx4 v6, s[52:55], s39 offen lds
    s_add_u32 m0, s8, 69632
    s_add_u32 s39, s9, 0
    buffer_load_dwordx4 v6, s[56:59], s39 offen lds
    s_add_u32 m0, s8, 73728
    s_add_u32 s39, s9, 57344
    buffer_load_dwordx4 v6, s[52:55], s39 offen lds
    s_add_u32 m0, s8, 77824
    s_add_u32 s39, s9, 57344
    buffer_load_dwordx4 v6, s[56:59], s39 offen lds
    s_add_u32 m0, s8, 81920
    s_add_u32 s39, s9, 114688
    buffer_load_dwordx4 v6, s[52:55], s39 offen lds
    s_add_u32 m0, s8, 86016
    s_add_u32 s39, s9, 114688
    buffer_load_dwordx4 v6, s[56:59], s39 offen lds
    s_add_u32 m0, s8, 90112
    s_add_u32 s39, s9, 172032
    buffer_load_dwordx4 v6, s[52:55], s39 offen lds
    s_add_u32 m0, s8, 94208
    s_add_u32 s39, s9, 172032
    buffer_load_dwordx4 v6, s[56:59], s39 offen lds
    s_cmp_lg_u32 s32, 0
    s_cbranch_scc1 Lwg_5
    s_add_u32 s3, s10, 192
    v_mov_b32 v8, s3
    v_add_u32 v240, 1, v240
    v_add_u32 v241, 1, v241
    v_add_u32 v242, 1, v242
    v_add_u32 v243, 1, v243
    s_mov_b32 s3, 0
Lgl_6:
    buffer_load_dwordx4 v[248:251], v246, s[40:43], 0 offen sc1
    buffer_load_dword v1, v8, s[40:43], 0 offen sc1
    s_waitcnt vmcnt(1)
    v_xor_b32 v248, v248, v240
    v_xor_b32 v249, v249, v241
    v_xor_b32 v250, v250, v242
    v_xor_b32 v251, v251, v243
    v_bfi_b32 v251, v4, 0, v251
    v_or_b32 v248, v248, v249
    v_or3_b32 v248, v248, v250, v251
    v_cmp_ne_u32 vcc, 0, v248
    s_cbranch_vccz Lgd_7
    s_waitcnt vmcnt(0)
    v_cmp_gt_u32 vcc, 1, v1
    s_cbranch_vccz Lgd_7
    s_sleep 1
    s_add_u32 s3, s3, 1
    s_cmp_lt_u32 s3, 200000
    s_cbranch_scc1 Lgl_6
Lgd_7:
Lwg_5:
    s_waitcnt vmcnt(0)
    s_barrier
    s_add_u32 s44, s30, 0
    s_addc_u32 s45, s31, 0
    s_mov_b32 s46, 1892352
    s_mov_b32 s47, 0x00020000
    buffer_load_dwordx4 v[152:155], v10, s[44:47], 0 offen offset:0 sc1
    buffer_load_dwordx4 v[156:159], v10, s[44:47], 0 offen offset:2048 sc1
    s_lshl_b32 s3, s33, 7
    s_add_u32 s3, s3, 20480
    v_min_u32 v26, 80, v2
    v_add_u32 v26, s3, v26
    s_waitcnt vmcnt(0)
    ds_write_b128 v9, v[152:155] offset:16640
    ds_write_b128 v9, v[156:159] offset:18688
    s_waitcnt lgkmcnt(0)
    s_lshl_b32 s98, s96, 16
    s_and_b32 s99, s96, 0xffff0000
    s_cmp_eq_u32 s92, 0
    s_cselect_b32 s98, s98, s99
    s_mov_b32 s99, s98
    s_barrier
    ds_read_b64 v[32:33], v14 offset:0
    ds_read_b64 v[34:35], v14 offset:8
    ds_read_b128 v[64:67], v16 offset:3584
    ds_read_b64 v[36:37], v14 offset:512
    ds_read_b64 v[38:39], v14 offset:520
    ds_read_b128 v[68:71], v16 offset:3072
    ds_read_b64 v[40:41], v14 offset:1024
    ds_read_b64 v[42:43], v14 offset:1032
    ds_read_b128 v[72:75], v16 offset:2560
    ds_read_b64 v[44:45], v14 offset:1536
    ds_read_b64 v[46:47], v14 offset:1544
    ds_read_b128 v[76:79], v16 offset:2048
    s_waitcnt lgkmcnt(9)
    v_mfma_f32_16x16x32_bf16 v[160:163], v[32:35], v[64:67], 0
    s_waitcnt lgkmcnt(6)
    v_mfma_f32_16x16x32_bf16 v[164:167], v[36:39], v[64:67], 0
    v_mfma_f32_16x16x32_bf16 v[164:167], v[32:35], v[68:71], v[164:167]
    v_mfma_f32_16x16x32_bf16 v[168:171], v[36:39], v[68:71], 0
    s_waitcnt lgkmcnt(3)
    v_mfma_f32_16x16x32_bf16 v[168:171], v[40:43], v[64:67], v[168:171]
    s_add_u32 m0, s8, 98304
    s_add_u32 s39, s9, 229376
    buffer_load_dwordx4 v6, s[52:55], s39 offen lds
    v_mfma_f32_16x16x32_bf16 v[172:175], v[40:43], v[68:71], 0
    v_mfma_f32_16x16x32_bf16 v[168:171], v[32:35], v[72:75], v[168:171]
    ds_read_b64 v[96:97], v14 offset:128
    ds_read_b64 v[98:99], v14 offset:136
    ds_read_b128 v[128:131], v16 offset:3712
    v_mfma_f32_16x16x32_bf16 v[172:175], v[36:39], v[72:75], v[172:175]
    ds_read_b64 v[100:101], v14 offset:640
    ds_read_b64 v[102:103], v14 offset:648
    ds_read_b128 v[132:135], v16 offset:3200
    s_waitcnt lgkmcnt(0)
    v_mfma_f32_16x16x32_bf16 v[172:175], v[44:47], v[64:67], v[172:175]
    ds_read_b64 v[104:105], v14 offset:1152
    ds_read_b64 v[106:107], v14 offset:1160
    ds_read_b128 v[136:139], v16 offset:2688
    v_mfma_f32_16x16x32_bf16 v[172:175], v[32:35], v[76:79], v[172:175]
    ds_read_b64 v[108:109], v14 offset:1664
    ds_read_b64 v[110:111], v14 offset:1672
    ds_read_b128 v[140:143], v16 offset:2176
    s_add_u32 m0, s8, 102400
    s_add_u32 s39, s9, 229376
    buffer_load_dwordx4 v6, s[56:59], s39 offen lds
    s_waitcnt lgkmcnt(0)
    v_mfma_f32_16x16x32_bf16 v[160:163], v[96:99], v[128:131], v[160:163]
    ds_read_b64 v[32:33], v14 offset:256
    ds_read_b64 v[34:35], v14 offset:264
    v_mfma_f32_16x16x32_bf16 v[164:167], v[100:103], v[128:131], v[164:167]
    ds_read_b128 v[64:67], v16 offset:3840
    ds_read_b64 v[36:37], v14 offset:768
    v_mfma_f32_16x16x32_bf16 v[164:167], v[96:99], v[132:135], v[164:167]
    ds_read_b64 v[38:39], v14 offset:776
    ds_read_b128 v[68:71], v16 offset:3328
    v_mfma_f32_16x16x32_bf16 v[168:171], v[100:103], v[132:135], v[168:171]
    ds_read_b64 v[40:41], v14 offset:1280
    ds_read_b64 v[42:43], v14 offset:1288
    v_mfma_f32_16x16x32_bf16 v[168:171], v[104:107], v[128:131], v[168:171]
    ds_read_b128 v[72:75], v16 offset:2816
    ds_read_b64 v[44:45], v14 offset:1792
    s_add_u32 m0, s8, 106496
    s_add_u32 s39, s9, 286720
    buffer_load_dwordx4 v6, s[52:55], s39 offen lds
    v_mfma_f32_16x16x32_bf16 v[172:175], v[104:107], v[132:135], v[172:175]
    ds_read_b64 v[46:47], v14 offset:1800
    ds_read_b128 v[76:79], v16 offset:2304
    v_mfma_f32_16x16x32_bf16 v[168:171], v[96:99], v[136:139], v[168:171]
    v_mfma_f32_16x16x32_bf16 v[172:175], v[100:103], v[136:139], v[172:175]
    v_mfma_f32_16x16x32_bf16 v[172:175], v[108:111], v[128:131], v[172:175]
    v_mfma_f32_16x16x32_bf16 v[172:175], v[96:99], v[140:143], v[172:175]
    s_add_u32 m0, s8, 110592
    s_add_u32 s39, s9, 286720
    buffer_load_dwordx4 v6, s[56:59], s39 offen lds
    s_waitcnt lgkmcnt(0)
    v_mfma_f32_16x16x32_bf16 v[160:163], v[32:35], v[64:67], v[160:163]
    ds_read_b64 v[96:97], v14 offset:384
    ds_read_b64 v[98:99], v14 offset:392
    v_mfma_f32_16x16x32_bf16 v[164:167], v[36:39], v[64:67], v[164:167]
    ds_read_b128 v[128:131], v16 offset:3968
    ds_read_b64 v[100:101], v14 offset:896
    v_mfma_f32_16x16x32_bf16 v[164:167], v[32:35], v[68:71], v[164:167]
    ds_read_b64 v[102:103], v14 offset:904
    ds_read_b128 v[132:135], v16 offset:3456
    v_mfma_f32_16x16x32_bf16 v[168:171], v[36:39], v[68:71], v[168:171]
    ds_read_b64 v[104:105], v14 offset:1408
    ds_read_b64 v[106:107], v14 offset:1416
    v_mfma_f32_16x16x32_bf16 v[168:171], v[40:43], v[64:67], v[168:171]
    ds_read_b128 v[136:139], v16 offset:2944
    ds_read_b64 v[108:109], v14 offset:1920
    s_add_u32 m0, s8, 114688
    s_add_u32 s39, s9, 344064
    buffer_load_dwordx4 v6, s[52:55], s39 offen lds
    v_mfma_f32_16x16x32_bf16 v[172:175], v[40:43], v[68:71], v[172:175]
    ds_read_b64 v[110:111], v14 offset:1928
    ds_read_b128 v[140:143], v16 offset:2432
    v_mfma_f32_16x16x32_bf16 v[168:171], v[32:35], v[72:75], v[168:171]
    v_mfma_f32_16x16x32_bf16 v[172:175], v[36:39], v[72:75], v[172:175]
    v_mfma_f32_16x16x32_bf16 v[172:175], v[44:47], v[64:67], v[172:175]
    v_mfma_f32_16x16x32_bf16 v[172:175], v[32:35], v[76:79], v[172:175]
    s_add_u32 m0, s8, 118784
    s_add_u32 s39, s9, 344064
    buffer_load_dwordx4 v6, s[56:59], s39 offen lds
    s_waitcnt lgkmcnt(0)
    v_mfma_f32_16x16x32_bf16 v[160:163], v[96:99], v[128:131], v[160:163]
    ds_read_b64 v[32:33], v14 offset:0
    ds_read_b64 v[34:35], v14 offset:8
    ds_read_b128 v[64:67], v16 offset:3584
    v_mfma_f32_16x16x32_bf16 v[164:167], v[100:103], v[128:131], v[164:167]
    ds_read_b64 v[36:37], v14 offset:512
    ds_read_b64 v[38:39], v14 offset:520
    ds_read_b128 v[68:71], v16 offset:3072
    v_mfma_f32_16x16x32_bf16 v[164:167], v[96:99], v[132:135], v[164:167]
    ds_read_b64 v[40:41], v14 offset:1024
    ds_read_b64 v[42:43], v14 offset:1032
    ds_read_b128 v[72:75], v16 offset:2560
    v_mfma_f32_16x16x32_bf16 v[168:171], v[100:103], v[132:135], v[168:171]
    ds_read_b64 v[44:45], v14 offset:1536
    ds_read_b64 v[46:47], v14 offset:1544
    ds_read_b128 v[76:79], v16 offset:2048
    v_mfma_f32_16x16x32_bf16 v[168:171], v[104:107], v[128:131], v[168:171]
    ds_read_b64 v[48:49], v14 offset:2048
    ds_read_b64 v[50:51], v14 offset:2056
    ds_read_b128 v[80:83], v16 offset:1536
    s_add_u32 m0, s8, 122880
    s_add_u32 s39, s9, 401408
    buffer_load_dwordx4 v6, s[52:55], s39 offen lds
    v_mfma_f32_16x16x32_bf16 v[172:175], v[104:107], v[132:135], v[172:175]
    ds_read_b64 v[52:53], v14 offset:2560
    ds_read_b64 v[54:55], v14 offset:2568
    ds_read_b128 v[84:87], v16 offset:1024
    v_mfma_f32_16x16x32_bf16 v[168:171], v[96:99], v[136:139], v[168:171]
    ds_read_b64 v[56:57], v14 offset:3072
    ds_read_b64 v[58:59], v14 offset:3080
    ds_read_b128 v[88:91], v16 offset:512
    v_mfma_f32_16x16x32_bf16 v[172:175], v[100:103], v[136:139], v[172:175]
    ds_read_b64 v[60:61], v14 offset:3584
    ds_read_b64 v[62:63], v14 offset:3592
    ds_read_b128 v[92:95], v16 offset:0
    v_mfma_f32_16x16x32_bf16 v[172:175], v[108:111], v[128:131], v[172:175]
    v_mfma_f32_16x16x32_bf16 v[172:175], v[96:99], v[140:143], v[172:175]
    s_add_u32 m0, s8, 126976
    s_add_u32 s39, s9, 401408
    buffer_load_dwordx4 v6, s[56:59], s39 offen lds
    s_waitcnt lgkmcnt(0)
    v_mfma_f32_16x16x32_bf16 v[176:179], v[40:43], v[72:75], 0
    ds_read_b64 v[96:97], v14 offset:128
    v_mfma_f32_16x16x32_bf16 v[176:179], v[44:47], v[68:71], v[176:179]
    ds_read_b64 v[98:99], v14 offset:136
    v_mfma_f32_16x16x32_bf16 v[180:183], v[44:47], v[72:75], 0
    ds_read_b128 v[128:131], v16 offset:3712
    v_mfma_f32_16x16x32_bf16 v[176:179], v[36:39], v[76:79], v[176:179]
    ds_read_b64 v[100:101], v14 offset:640
    v_mfma_f32_16x16x32_bf16 v[180:183], v[40:43], v[76:79], v[180:183]
    ds_write_b128 v20, v[160:163] offset:0
    ds_write_b128 v20, v[164:167] offset:1024
    ds_write_b128 v20, v[168:171] offset:2048
    ds_write_b128 v20, v[172:175] offset:3072
    ds_read_b64 v[102:103], v14 offset:648
    s_add_u32 m0, s8, 131072
    s_add_u32 s39, s9, 458752
    buffer_load_dwordx4 v6, s[52:55], s39 offen lds
    v_mfma_f32_16x16x32_bf16 v[184:187], v[44:47], v[76:79], 0
    ds_read_b128 v[132:135], v16 offset:3200
    v_mfma_f32_16x16x32_bf16 v[176:179], v[48:51], v[64:67], v[176:179]
    ds_read_b64 v[104:105], v14 offset:1152
    v_mfma_f32_16x16x32_bf16 v[180:183], v[48:51], v[68:71], v[180:183]
    ds_read_b64 v[106:107], v14 offset:1160
    v_mfma_f32_16x16x32_bf16 v[184:187], v[48:51], v[72:75], v[184:187]
    ds_read_b128 v[136:139], v16 offset:2688
    v_mfma_f32_16x16x32_bf16 v[188:191], v[48:51], v[76:79], 0
    ds_read_b64 v[108:109], v14 offset:1664
    s_add_u32 m0, s8, 135168
    s_add_u32 s39, s9, 458752
    buffer_load_dwordx4 v6, s[56:59], s39 offen lds
    v_mfma_f32_16x16x32_bf16 v[176:179], v[32:35], v[80:83], v[176:179]
    s_waitcnt lgkmcnt(0)
    s_barrier
    ds_read_b128 v[192:195], v21 offset:0
    ds_read_b128 v[196:199], v21 offset:4096
    ds_read_b64 v[22:23], v18 offset:3584
    ds_read_b128 v[200:203], v21 offset:1024
    ds_read_b128 v[204:207], v21 offset:5120
    ds_read_b64 v[24:25], v18 offset:3072
    ds_read_b64 v[110:111], v14 offset:1672
    v_mfma_f32_16x16x32_bf16 v[180:183], v[36:39], v[80:83], v[180:183]
    ds_read_b128 v[140:143], v16 offset:2176
    v_mfma_f32_16x16x32_bf16 v[184:187], v[40:43], v[80:83], v[184:187]
    ds_read_b64 v[112:113], v14 offset:2176
    v_mfma_f32_16x16x32_bf16 v[188:191], v[44:47], v[80:83], v[188:191]
    ds_read_b64 v[114:115], v14 offset:2184
    v_mfma_f32_16x16x32_bf16 v[180:183], v[52:55], v[64:67], v[180:183]
    ds_read_b128 v[144:147], v16 offset:1664
    s_add_u32 m0, s8, 139264
    s_add_u32 s39, s9, 516096
    buffer_load_dwordx4 v6, s[52:55], s39 offen lds
    v_mfma_f32_16x16x32_bf16 v[184:187], v[52:55], v[68:71], v[184:187]
    ds_read_b64 v[116:117], v14 offset:2688
    v_mfma_f32_16x16x32_bf16 v[188:191], v[52:55], v[72:75], v[188:191]
    ds_read_b64 v[118:119], v14 offset:2696
    v_mfma_f32_16x16x32_bf16 v[180:183], v[32:35], v[84:87], v[180:183]
    ds_read_b128 v[148:151], v16 offset:1152
    v_mfma_f32_16x16x32_bf16 v[184:187], v[36:39], v[84:87], v[184:187]
    ds_read_b64 v[120:121], v14 offset:3200
    v_mfma_f32_16x16x32_bf16 v[188:191], v[40:43], v[84:87], v[188:191]
    ds_read_b64 v[122:123], v14 offset:3208
    s_add_u32 m0, s8, 143360
    s_add_u32 s39, s9, 516096
    buffer_load_dwordx4 v6, s[56:59], s39 offen lds
    v_mfma_f32_16x16x32_bf16 v[184:187], v[56:59], v[64:67], v[184:187]
    ds_read_b128 v[152:155], v16 offset:640
    v_mfma_f32_16x16x32_bf16 v[188:191], v[56:59], v[68:71], v[188:191]
    ds_read_b64 v[124:125], v14 offset:3712
    v_mfma_f32_16x16x32_bf16 v[184:187], v[32:35], v[88:91], v[184:187]
    ds_read_b64 v[126:127], v14 offset:3720
    v_mfma_f32_16x16x32_bf16 v[188:191], v[36:39], v[88:91], v[188:191]
    ds_read_b128 v[156:159], v16 offset:128
    v_mfma_f32_16x16x32_bf16 v[188:191], v[60:63], v[64:67], v[188:191]
    s_add_u32 m0, s8, 147456
    s_add_u32 s39, s9, 573440
    buffer_load_dwordx4 v6, s[52:55], s39 offen lds
    v_mfma_f32_16x16x32_bf16 v[188:191], v[32:35], v[92:95], v[188:191]
    s_waitcnt lgkmcnt(0)
    v_mfma_f32_16x16x32_bf16 v[176:179], v[104:107], v[136:139], v[176:179]
    ds_read_b64 v[32:33], v14 offset:256
    v_and_b32 v160, 0xffff0000, v23
    v_lshlrev_b32 v161, 16, v23
    v_mfma_f32_16x16x32_bf16 v[176:179], v[108:111], v[132:135], v[176:179]
    ds_read_b64 v[34:35], v14 offset:264
    v_and_b32 v162, 0xffff0000, v22
    v_lshlrev_b32 v163, 16, v22
    v_mfma_f32_16x16x32_bf16 v[180:183], v[108:111], v[136:139], v[180:183]
    ds_read_b128 v[64:67], v16 offset:3840
    v_and_b32 v164, 0xffff0000, v25
    v_lshlrev_b32 v165, 16, v25
    v_mfma_f32_16x16x32_bf16 v[176:179], v[100:103], v[140:143], v[176:179]
    ds_read_b64 v[36:37], v14 offset:768
    v_and_b32 v166, 0xffff0000, v24
    v_lshlrev_b32 v167, 16, v24
    s_add_u32 m0, s8, 151552
    s_add_u32 s39, s9, 573440
    buffer_load_dwordx4 v6, s[56:59], s39 offen lds
    v_mfma_f32_16x16x32_bf16 v[180:183], v[104:107], v[140:143], v[180:183]
    ds_read_b64 v[38:39], v14 offset:776
    v_pk_mul_f32 v[160:161], v[160:161], s[98:99]
    v_pk_mul_f32 v[162:163], v[162:163], s[98:99]
    v_mfma_f32_16x16x32_bf16 v[184:187], v[108:111], v[140:143], v[184:187]
    ds_read_b128 v[68:71], v16 offset:3328
    v_pk_mul_f32 v[164:165], v[164:165], s[98:99]
    v_pk_mul_f32 v[166:167], v[166:167], s[98:99]
    v_mfma_f32_16x16x32_bf16 v[176:179], v[112:115], v[128:131], v[176:179]
    ds_read_b64 v[40:41], v14 offset:1280
    v_pk_add_f32 v[192:193], v[192:193], v[196:197]
    v_pk_add_f32 v[194:195], v[194:195], v[198:199]
    v_mfma_f32_16x16x32_bf16 v[180:183], v[112:115], v[132:135], v[180:183]
    ds_read_b64 v[42:43], v14 offset:1288
    v_pk_add_f32 v[200:201], v[200:201], v[204:205]
    v_pk_add_f32 v[202:203], v[202:203], v[206:207]
    v_mfma_f32_16x16x32_bf16 v[184:187], v[112:115], v[136:139], v[184:187]
    ds_read_b128 v[72:75], v16 offset:2816
    v_cvt_pk_bf16_f32 v168, v160, v161
    v_cvt_pk_bf16_f32 v169, v162, v163
    s_add_u32 m0, s8, 155648
    s_add_u32 s39, s9, 630784
    buffer_load_dwordx4 v6, s[52:55], s39 offen lds
    v_mfma_f32_16x16x32_bf16 v[188:191], v[112:115], v[140:143], v[188:191]
    ds_read_b64 v[44:45], v14 offset:1792
    v_cvt_pk_bf16_f32 v170, v164, v165
    v_cvt_pk_bf16_f32 v171, v166, v167
    v_mfma_f32_16x16x32_bf16 v[176:179], v[96:99], v[144:147], v[176:179]
    ds_read_b64 v[46:47], v14 offset:1800
    v_lshlrev_b32 v160, 16, v168
    v_and_b32 v161, 0xffff0000, v168
    v_mfma_f32_16x16x32_bf16 v[180:183], v[100:103], v[144:147], v[180:183]
    ds_read_b128 v[76:79], v16 offset:2304
    v_lshlrev_b32 v162, 16, v169
    v_and_b32 v163, 0xffff0000, v169
    v_mfma_f32_16x16x32_bf16 v[184:187], v[104:107], v[144:147], v[184:187]
    ds_read_b64 v[48:49], v14 offset:2304
    v_lshlrev_b32 v164, 16, v170
    v_and_b32 v165, 0xffff0000, v170
    v_mfma_f32_16x16x32_bf16 v[188:191], v[108:111], v[144:147], v[188:191]
    ds_read_b64 v[50:51], v14 offset:2312
    v_lshlrev_b32 v166, 16, v171
    v_and_b32 v167, 0xffff0000, v171
    s_add_u32 m0, s8, 159744
    s_add_u32 s39, s9, 630784
    buffer_load_dwordx4 v6, s[56:59], s39 offen lds
    v_mfma_f32_16x16x32_bf16 v[180:183], v[116:119], v[128:131], v[180:183]
    ds_read_b128 v[80:83], v16 offset:1792
    v_cvt_pk_bf16_f32 v168, v192, v193
    v_cvt_pk_bf16_f32 v169, v194, v195
    v_mfma_f32_16x16x32_bf16 v[184:187], v[116:119], v[132:135], v[184:187]
    ds_read_b64 v[52:53], v14 offset:2816
    v_cvt_pk_bf16_f32 v170, v200, v201
    v_cvt_pk_bf16_f32 v171, v202, v203
    v_mfma_f32_16x16x32_bf16 v[188:191], v[116:119], v[136:139], v[188:191]
    ds_read_b64 v[54:55], v14 offset:2824
    v_lshlrev_b32 v192, 16, v168
    v_and_b32 v193, 0xffff0000, v168
    v_mfma_f32_16x16x32_bf16 v[180:183], v[96:99], v[148:151], v[180:183]
    ds_read_b128 v[84:87], v16 offset:1280
    v_lshlrev_b32 v194, 16, v169
    v_and_b32 v195, 0xffff0000, v169
    v_mfma_f32_16x16x32_bf16 v[184:187], v[100:103], v[148:151], v[184:187]
    ds_read_b64 v[56:57], v14 offset:3328
    v_lshlrev_b32 v200, 16, v170
    v_and_b32 v201, 0xffff0000, v170
    v_mfma_f32_16x16x32_bf16 v[188:191], v[104:107], v[148:151], v[188:191]
    ds_read_b64 v[58:59], v14 offset:3336
    v_lshlrev_b32 v202, 16, v171
    v_and_b32 v203, 0xffff0000, v171
    v_mfma_f32_16x16x32_bf16 v[184:187], v[120:123], v[128:131], v[184:187]
    ds_read_b128 v[88:91], v16 offset:768
    v_pk_add_f32 v[192:193], v[192:193], v[160:161]
    v_pk_add_f32 v[194:195], v[194:195], v[162:163]
    v_mfma_f32_16x16x32_bf16 v[188:191], v[120:123], v[132:135], v[188:191]
    ds_read_b64 v[60:61], v14 offset:3840
    v_pk_add_f32 v[200:201], v[200:201], v[164:165]
    v_pk_add_f32 v[202:203], v[202:203], v[166:167]
    v_mfma_f32_16x16x32_bf16 v[184:187], v[96:99], v[152:155], v[184:187]
    ds_read_b64 v[62:63], v14 offset:3848
    v_cvt_pk_bf16_f32 v172, v192, v193
    v_cvt_pk_bf16_f32 v173, v194, v195
    v_mfma_f32_16x16x32_bf16 v[188:191], v[100:103], v[152:155], v[188:191]
    ds_read_b128 v[92:95], v16 offset:256
    v_cvt_pk_bf16_f32 v174, v200, v201
    v_cvt_pk_bf16_f32 v175, v202, v203
    v_mfma_f32_16x16x32_bf16 v[188:191], v[124:127], v[128:131], v[188:191]
    s_mov_b32 s97, 0
    s_nop 0
    v_mfma_f32_16x16x32_bf16 v[188:191], v[96:99], v[156:159], v[188:191]
    v_permlane16_swap_b32 v172, v174
    v_permlane16_swap_b32 v173, v175
    buffer_store_dwordx4 v[172:175], v19, s[48:51], s97 offen sc1
    s_waitcnt lgkmcnt(0)
    s_barrier
    v_mfma_f32_16x16x32_bf16 v[176:179], v[40:43], v[72:75], v[176:179]
    ds_read_b64 v[96:97], v14 offset:384
    v_mfma_f32_16x16x32_bf16 v[176:179], v[44:47], v[68:71], v[176:179]
    ds_read_b64 v[98:99], v14 offset:392
    v_mfma_f32_16x16x32_bf16 v[180:183], v[44:47], v[72:75], v[180:183]
    ds_read_b128 v[128:131], v16 offset:3968
    v_mfma_f32_16x16x32_bf16 v[176:179], v[36:39], v[76:79], v[176:179]
    ds_read_b64 v[100:101], v14 offset:896
    v_mfma_f32_16x16x32_bf16 v[180:183], v[40:43], v[76:79], v[180:183]
    ds_read_b64 v[102:103], v14 offset:904
    v_mfma_f32_16x16x32_bf16 v[184:187], v[44:47], v[76:79], v[184:187]
    ds_read_b128 v[132:135], v16 offset:3456
    v_mfma_f32_16x16x32_bf16 v[176:179], v[48:51], v[64:67], v[176:179]
    ds_read_b64 v[104:105], v14 offset:1408
    v_mfma_f32_16x16x32_bf16 v[180:183], v[48:51], v[68:71], v[180:183]
    ds_read_b64 v[106:107], v14 offset:1416
    v_mfma_f32_16x16x32_bf16 v[184:187], v[48:51], v[72:75], v[184:187]
    ds_read_b128 v[136:139], v16 offset:2944
    v_mfma_f32_16x16x32_bf16 v[188:191], v[48:51], v[76:79], v[188:191]
    ds_read_b64 v[108:109], v14 offset:1920
    v_mfma_f32_16x16x32_bf16 v[176:179], v[32:35], v[80:83], v[176:179]
    ds_read_b64 v[110:111], v14 offset:1928
    v_mfma_f32_16x16x32_bf16 v[180:183], v[36:39], v[80:83], v[180:183]
    ds_read_b128 v[140:143], v16 offset:2432
    v_mfma_f32_16x16x32_bf16 v[184:187], v[40:43], v[80:83], v[184:187]
    ds_read_b64 v[112:113], v14 offset:2432
    v_mfma_f32_16x16x32_bf16 v[188:191], v[44:47], v[80:83], v[188:191]
    ds_read_b64 v[114:115], v14 offset:2440
    v_mfma_f32_16x16x32_bf16 v[180:183], v[52:55], v[64:67], v[180:183]
    ds_read_b128 v[144:147], v16 offset:1920
    v_mfma_f32_16x16x32_bf16 v[184:187], v[52:55], v[68:71], v[184:187]
    ds_read_b64 v[116:117], v14 offset:2944
    v_mfma_f32_16x16x32_bf16 v[188:191], v[52:55], v[72:75], v[188:191]
    ds_read_b64 v[118:119], v14 offset:2952
    v_mfma_f32_16x16x32_bf16 v[180:183], v[32:35], v[84:87], v[180:183]
    ds_read_b128 v[148:151], v16 offset:1408
    v_mfma_f32_16x16x32_bf16 v[184:187], v[36:39], v[84:87], v[184:187]
    ds_read_b64 v[120:121], v14 offset:3456
    v_mfma_f32_16x16x32_bf16 v[188:191], v[40:43], v[84:87], v[188:191]
    ds_read_b64 v[122:123], v14 offset:3464
    v_mfma_f32_16x16x32_bf16 v[184:187], v[56:59], v[64:67], v[184:187]
    ds_read_b128 v[152:155], v16 offset:896
    v_mfma_f32_16x16x32_bf16 v[188:191], v[56:59], v[68:71], v[188:191]
    ds_read_b64 v[124:125], v14 offset:3968
    v_mfma_f32_16x16x32_bf16 v[184:187], v[32:35], v[88:91], v[184:187]
    ds_read_b64 v[126:127], v14 offset:3976
    v_mfma_f32_16x16x32_bf16 v[188:191], v[36:39], v[88:91], v[188:191]
    ds_read_b128 v[156:159], v16 offset:384
    v_mfma_f32_16x16x32_bf16 v[188:191], v[60:63], v[64:67], v[188:191]
    v_mfma_f32_16x16x32_bf16 v[188:191], v[32:35], v[92:95], v[188:191]
    s_waitcnt lgkmcnt(0)
    buffer_load_dword v27, v26, s[40:43], 0 offen sc1
    v_mfma_f32_16x16x32_bf16 v[176:179], v[104:107], v[136:139], v[176:179]
    v_mfma_f32_16x16x32_bf16 v[176:179], v[108:111], v[132:135], v[176:179]
    v_mfma_f32_16x16x32_bf16 v[180:183], v[108:111], v[136:139], v[180:183]
    v_mfma_f32_16x16x32_bf16 v[176:179], v[100:103], v[140:143], v[176:179]
    v_mfma_f32_16x16x32_bf16 v[180:183], v[104:107], v[140:143], v[180:183]
    v_mfma_f32_16x16x32_bf16 v[184:187], v[108:111], v[140:143], v[184:187]
    v_mfma_f32_16x16x32_bf16 v[176:179], v[112:115], v[128:131], v[176:179]
    v_mfma_f32_16x16x32_bf16 v[180:183], v[112:115], v[132:135], v[180:183]
    v_mfma_f32_16x16x32_bf16 v[184:187], v[112:115], v[136:139], v[184:187]
    v_mfma_f32_16x16x32_bf16 v[188:191], v[112:115], v[140:143], v[188:191]
    v_mfma_f32_16x16x32_bf16 v[176:179], v[96:99], v[144:147], v[176:179]
    v_mfma_f32_16x16x32_bf16 v[180:183], v[100:103], v[144:147], v[180:183]
    v_mfma_f32_16x16x32_bf16 v[184:187], v[104:107], v[144:147], v[184:187]
    v_mfma_f32_16x16x32_bf16 v[188:191], v[108:111], v[144:147], v[188:191]
    v_mfma_f32_16x16x32_bf16 v[180:183], v[116:119], v[128:131], v[180:183]
    v_mfma_f32_16x16x32_bf16 v[184:187], v[116:119], v[132:135], v[184:187]
    v_mfma_f32_16x16x32_bf16 v[188:191], v[116:119], v[136:139], v[188:191]
    v_mfma_f32_16x16x32_bf16 v[180:183], v[96:99], v[148:151], v[180:183]
    v_mfma_f32_16x16x32_bf16 v[184:187], v[100:103], v[148:151], v[184:187]
    v_mfma_f32_16x16x32_bf16 v[188:191], v[104:107], v[148:151], v[188:191]
    v_mfma_f32_16x16x32_bf16 v[184:187], v[120:123], v[128:131], v[184:187]
    v_mfma_f32_16x16x32_bf16 v[188:191], v[120:123], v[132:135], v[188:191]
    v_mfma_f32_16x16x32_bf16 v[184:187], v[96:99], v[152:155], v[184:187]
    v_mfma_f32_16x16x32_bf16 v[188:191], v[100:103], v[152:155], v[188:191]
    v_mfma_f32_16x16x32_bf16 v[188:191], v[124:127], v[128:131], v[188:191]
    v_mfma_f32_16x16x32_bf16 v[188:191], v[96:99], v[156:159], v[188:191]
    s_nop 7
    ds_write_b128 v20, v[176:179] offset:0
    ds_write_b128 v20, v[180:183] offset:1024
    ds_write_b128 v20, v[184:187] offset:2048
    ds_write_b128 v20, v[188:191] offset:3072
    s_waitcnt vmcnt(0)
    v_cmp_gt_u32 vcc, 1, v27
    s_cbranch_vccz Lsdn_9
    s_mov_b32 s3, 0
Lslp_8:
    buffer_load_dword v27, v26, s[40:43], 0 offen sc1
    s_waitcnt vmcnt(0)
    v_cmp_gt_u32 vcc, 1, v27
    s_cbranch_vccz Lsdn_9
    s_sleep 1
    s_add_u32 s3, s3, 1
    s_cmp_lt_u32 s3, 200000
    s_cbranch_scc1 Lslp_8
Lsdn_9:
    s_add_u32 s44, s30, 4194304
    s_addc_u32 s45, s31, 0
    s_mov_b32 s46, 5376
    s_mov_b32 s47, 0x00020000
    buffer_load_dwordx4 v[216:219], v5, s[44:47], 0 offen offset:896 sc1
    buffer_load_dwordx4 v[220:223], v5, s[44:47], 0 offen offset:0 sc1
    buffer_load_dwordx4 v[224:227], v5, s[44:47], 0 offen offset:1792 sc1
    buffer_load_dwordx4 v[228:231], v5, s[44:47], 0 offen offset:3584 sc1
    buffer_load_dwordx4 v[232:235], v5, s[44:47], 0 offen offset:2688 sc1
    s_waitcnt vmcnt(6) lgkmcnt(0)
    s_barrier
    ds_read_b128 v[192:195], v21 offset:0
    ds_read_b128 v[196:199], v21 offset:4096
    ds_read_b64 v[22:23], v18 offset:1536
    ds_read_b128 v[200:203], v21 offset:1024
    ds_read_b128 v[204:207], v21 offset:5120
    ds_read_b64 v[24:25], v18 offset:1024
    s_cmp_lg_u32 s32, 0
    s_cbranch_scc1 Lpub_10
    v_mov_b32 v1, 1
    s_mov_b64 exec, 0xffff
    s_lshl_b32 s3, s37, 2
    v_lshl_add_u32 v15, v2, 8, s3
    buffer_store_dword v1, v15, s[40:43], 0 offen sc1
    s_mov_b64 exec, -1
Lpub_10:
    s_lshl_b32 s3, s33, 10
    v_add_u32 v8, s3, v5
    s_waitcnt lgkmcnt(0)
    v_and_b32 v160, 0xffff0000, v23
    v_lshlrev_b32 v161, 16, v23
    v_and_b32 v162, 0xffff0000, v22
    v_lshlrev_b32 v163, 16, v22
    v_and_b32 v164, 0xffff0000, v25
    v_lshlrev_b32 v165, 16, v25
    v_and_b32 v166, 0xffff0000, v24
    v_lshlrev_b32 v167, 16, v24
    v_pk_mul_f32 v[160:161], v[160:161], s[98:99]
    v_pk_mul_f32 v[162:163], v[162:163], s[98:99]
    v_pk_mul_f32 v[164:165], v[164:165], s[98:99]
    v_pk_mul_f32 v[166:167], v[166:167], s[98:99]
    v_pk_add_f32 v[192:193], v[192:193], v[196:197]
    v_pk_add_f32 v[194:195], v[194:195], v[198:199]
    v_pk_add_f32 v[200:201], v[200:201], v[204:205]
    v_pk_add_f32 v[202:203], v[202:203], v[206:207]
    v_cvt_pk_bf16_f32 v168, v160, v161
    v_cvt_pk_bf16_f32 v169, v162, v163
    v_cvt_pk_bf16_f32 v170, v164, v165
    v_cvt_pk_bf16_f32 v171, v166, v167
    v_lshlrev_b32 v160, 16, v168
    v_and_b32 v161, 0xffff0000, v168
    v_lshlrev_b32 v162, 16, v169
    v_and_b32 v163, 0xffff0000, v169
    v_lshlrev_b32 v164, 16, v170
    v_and_b32 v165, 0xffff0000, v170
    v_lshlrev_b32 v166, 16, v171
    v_and_b32 v167, 0xffff0000, v171
    v_cvt_pk_bf16_f32 v168, v192, v193
    v_cvt_pk_bf16_f32 v169, v194, v195
    v_cvt_pk_bf16_f32 v170, v200, v201
    v_cvt_pk_bf16_f32 v171, v202, v203
    v_lshlrev_b32 v192, 16, v168
    v_and_b32 v193, 0xffff0000, v168
    v_lshlrev_b32 v194, 16, v169
    v_and_b32 v195, 0xffff0000, v169
    v_lshlrev_b32 v200, 16, v170
    v_and_b32 v201, 0xffff0000, v170
    v_lshlrev_b32 v202, 16, v171
    v_and_b32 v203, 0xffff0000, v171
    v_pk_add_f32 v[192:193], v[192:193], v[160:161]
    v_pk_add_f32 v[194:195], v[194:195], v[162:163]
    v_pk_add_f32 v[200:201], v[200:201], v[164:165]
    v_pk_add_f32 v[202:203], v[202:203], v[166:167]
    v_cvt_pk_bf16_f32 v172, v192, v193
    v_cvt_pk_bf16_f32 v173, v194, v195
    v_cvt_pk_bf16_f32 v174, v200, v201
    v_cvt_pk_bf16_f32 v175, v202, v203
    s_mov_b32 s97, 917504
    s_nop 0
    v_permlane16_swap_b32 v172, v174
    v_permlane16_swap_b32 v173, v175
    buffer_store_dwordx4 v[172:175], v19, s[48:51], s97 offen sc1
    s_waitcnt vmcnt(0) lgkmcnt(0)
    s_barrier
    s_cmp_lg_u32 s32, 0
    s_cbranch_scc1 Lpub_11
    v_mov_b32 v1, 2
    s_mov_b64 exec, 0xffff
    s_lshl_b32 s3, s37, 2
    v_lshl_add_u32 v15, v2, 8, s3
    buffer_store_dword v1, v15, s[40:43], 0 offen sc1
    s_mov_b64 exec, -1
Lpub_11:
    ds_read_b64_tr_b16 a[0:1], v7 offset:0
    ds_read_b64_tr_b16 a[2:3], v7 offset:1024
    ds_read_b64_tr_b16 a[4:5], v7 offset:4096
    ds_read_b64_tr_b16 a[6:7], v7 offset:5120
    ds_read_b64_tr_b16 a[8:9], v7 offset:8192
    ds_read_b64_tr_b16 a[10:11], v7 offset:9216
    ds_read_b64_tr_b16 a[12:13], v7 offset:12288
    ds_read_b64_tr_b16 a[14:15], v7 offset:13312
    ds_read_b64_tr_b16 a[16:17], v7 offset:16384
    ds_read_b64_tr_b16 a[18:19], v7 offset:17408
    ds_read_b64_tr_b16 a[20:21], v7 offset:20480
    ds_read_b64_tr_b16 a[22:23], v7 offset:21504
    ds_read_b64_tr_b16 a[24:25], v7 offset:24576
    ds_read_b64_tr_b16 a[26:27], v7 offset:25600
    ds_read_b64_tr_b16 a[28:29], v7 offset:28672
    ds_read_b64_tr_b16 a[30:31], v7 offset:29696
    ds_read_b64_tr_b16 a[32:33], v7 offset:32768
    ds_read_b64_tr_b16 a[34:35], v7 offset:33792
    ds_read_b64_tr_b16 a[36:37], v7 offset:36864
    ds_read_b64_tr_b16 a[38:39], v7 offset:37888
    ds_read_b64_tr_b16 a[40:41], v7 offset:40960
    ds_read_b64_tr_b16 a[42:43], v7 offset:41984
    ds_read_b64_tr_b16 a[44:45], v7 offset:45056
    ds_read_b64_tr_b16 a[46:47], v7 offset:46080
    ds_read_b64_tr_b16 a[48:49], v7 offset:49152
    ds_read_b64_tr_b16 a[50:51], v7 offset:50176
    ds_read_b64_tr_b16 a[52:53], v7 offset:53248
    ds_read_b64_tr_b16 a[54:55], v7 offset:54272
    ds_read_b64_tr_b16 a[56:57], v7 offset:57344
    ds_read_b64_tr_b16 a[58:59], v7 offset:58368
    ds_read_b64_tr_b16 a[60:61], v7 offset:61440
    ds_read_b64_tr_b16 a[62:63], v7 offset:62464
    ds_read_b64_tr_b16 a[64:65], v3 offset:16384
    ds_read_b64_tr_b16 a[66:67], v3 offset:17408
    ds_read_b64_tr_b16 a[68:69], v3 offset:20480
    ds_read_b64_tr_b16 a[70:71], v3 offset:21504
    ds_read_b64_tr_b16 a[72:73], v3 offset:24576
    ds_read_b64_tr_b16 a[74:75], v3 offset:25600
    ds_read_b64_tr_b16 a[76:77], v3 offset:28672
    ds_read_b64_tr_b16 a[78:79], v3 offset:29696
    ds_read_b64_tr_b16 a[80:81], v3 offset:32768
    ds_read_b64_tr_b16 a[82:83], v3 offset:33792
    ds_read_b64_tr_b16 a[84:85], v3 offset:36864
    ds_read_b64_tr_b16 a[86:87], v3 offset:37888
    ds_read_b64_tr_b16 a[88:89], v3 offset:40960
    ds_read_b64_tr_b16 a[90:91], v3 offset:41984
    ds_read_b64_tr_b16 a[92:93], v3 offset:45056
    ds_read_b64_tr_b16 a[94:95], v3 offset:46080
    s_waitcnt lgkmcnt(0)
    s_barrier
    v_lshlrev_b32 v16, 16, v208
    v_lshlrev_b32 v80, 16, v212
    v_and_b32 v17, 0xffff0000, v208
    v_and_b32 v81, 0xffff0000, v212
    v_lshlrev_b32 v18, 16, v209
    v_lshlrev_b32 v82, 16, v213
    v_and_b32 v19, 0xffff0000, v209
    v_and_b32 v83, 0xffff0000, v213
    v_lshlrev_b32 v20, 16, v210
    v_lshlrev_b32 v84, 16, v214
    v_and_b32 v21, 0xffff0000, v210
    v_and_b32 v85, 0xffff0000, v214
    s_add_u32 m0, s8, 65536
    s_add_u32 s39, s9, 688128
    buffer_load_dwordx4 v6, s[52:55], s39 offen lds
    v_lshlrev_b32 v22, 16, v211
    v_lshlrev_b32 v86, 16, v215
    v_and_b32 v23, 0xffff0000, v211
    v_and_b32 v87, 0xffff0000, v215
    s_nop 0
    s_nop 0
    v_readlane_b32 s92, v16, 0
    v_readlane_b32 s12, v80, 0
    s_nop 0
    s_nop 0
    s_mov_b32 s93, s92
    s_mov_b32 s13, s12
    s_add_u32 m0, s8, 69632
    s_add_u32 s39, s9, 688128
    buffer_load_dwordx4 v6, s[56:59], s39 offen lds
    s_nop 1
    s_nop 1
    v_pk_add_f32 v[32:33], v[16:17], s[92:93] neg_lo:[0,1] neg_hi:[0,1]
    v_pk_add_f32 v[96:97], v[80:81], s[12:13] neg_lo:[0,1] neg_hi:[0,1]
    v_pk_add_f32 v[34:35], v[18:19], s[92:93] neg_lo:[0,1] neg_hi:[0,1]
    v_pk_add_f32 v[98:99], v[82:83], s[12:13] neg_lo:[0,1] neg_hi:[0,1]
    v_pk_add_f32 v[36:37], v[20:21], s[92:93] neg_lo:[0,1] neg_hi:[0,1]
    v_pk_add_f32 v[100:101], v[84:85], s[12:13] neg_lo:[0,1] neg_hi:[0,1]
    v_pk_add_f32 v[38:39], v[22:23], s[92:93] neg_lo:[0,1] neg_hi:[0,1]
    v_pk_add_f32 v[102:103], v[86:87], s[12:13] neg_lo:[0,1] neg_hi:[0,1]
    v_pk_mul_f32 v[50:51], v[32:33], v[32:33]
    v_pk_mul_f32 v[114:115], v[96:97], v[96:97]
    s_add_u32 m0, s8, 73728
    s_add_u32 s39, s9, 745472
    buffer_load_dwordx4 v6, s[52:55], s39 offen lds
    v_pk_add_f32 v[48:49], v[32:33], v[34:35]
    v_pk_add_f32 v[112:113], v[96:97], v[98:99]
    v_pk_fma_f32 v[50:51], v[34:35], v[34:35], v[50:51]
    v_pk_fma_f32 v[114:115], v[98:99], v[98:99], v[114:115]
    v_pk_add_f32 v[48:49], v[48:49], v[36:37]
    v_pk_add_f32 v[112:113], v[112:113], v[100:101]
    v_pk_fma_f32 v[50:51], v[36:37], v[36:37], v[50:51]
    v_pk_fma_f32 v[114:115], v[100:101], v[100:101], v[114:115]
    v_pk_add_f32 v[48:49], v[48:49], v[38:39]
    v_pk_add_f32 v[112:113], v[112:113], v[102:103]
    v_pk_fma_f32 v[50:51], v[38:39], v[38:39], v[50:51]
    v_pk_fma_f32 v[114:115], v[102:103], v[102:103], v[114:115]
    s_add_u32 m0, s8, 77824
    s_add_u32 s39, s9, 745472
    buffer_load_dwordx4 v6, s[56:59], s39 offen lds
    v_add_f32 v48, v48, v49
    v_add_f32 v112, v112, v113
    v_add_f32 v50, v50, v51
    v_add_f32 v114, v114, v115
    v_cndmask_b32 v48, 0, v48, s[6:7]
    v_cndmask_b32 v112, 0, v112, s[6:7]
    v_cndmask_b32 v50, 0, v50, s[6:7]
    v_cndmask_b32 v114, 0, v114, s[6:7]
    s_nop 1
    s_nop 1
    v_add_f32 v48, v48, v48 quad_perm:[1,0,3,2] row_mask:0xf bank_mask:0xf
    v_add_f32 v112, v112, v112 quad_perm:[1,0,3,2] row_mask:0xf bank_mask:0xf
    s_add_u32 m0, s8, 81920
    s_add_u32 s39, s9, 802816
    buffer_load_dwordx4 v6, s[52:55], s39 offen lds
    v_add_f32 v50, v50, v50 quad_perm:[1,0,3,2] row_mask:0xf bank_mask:0xf
    v_add_f32 v114, v114, v114 quad_perm:[1,0,3,2] row_mask:0xf bank_mask:0xf
    s_nop 0
    s_nop 0
    v_add_f32 v48, v48, v48 quad_perm:[2,3,0,1] row_mask:0xf bank_mask:0xf
    v_add_f32 v112, v112, v112 quad_perm:[2,3,0,1] row_mask:0xf bank_mask:0xf
    v_add_f32 v50, v50, v50 quad_perm:[2,3,0,1] row_mask:0xf bank_mask:0xf
    v_add_f32 v114, v114, v114 quad_perm:[2,3,0,1] row_mask:0xf bank_mask:0xf
    s_nop 0
    s_nop 0
    v_add_f32 v48, v48, v48 row_half_mirror row_mask:0xf bank_mask:0xf
    v_add_f32 v112, v112, v112 row_half_mirror row_mask:0xf bank_mask:0xf
    s_add_u32 m0, s8, 86016
    s_add_u32 s39, s9, 802816
    buffer_load_dwordx4 v6, s[56:59], s39 offen lds
    v_add_f32 v50, v50, v50 row_half_mirror row_mask:0xf bank_mask:0xf
    v_add_f32 v114, v114, v114 row_half_mirror row_mask:0xf bank_mask:0xf
    s_nop 0
    s_nop 0
    v_add_f32 v48, v48, v48 row_mirror row_mask:0xf bank_mask:0xf
    v_add_f32 v112, v112, v112 row_mirror row_mask:0xf bank_mask:0xf
    v_add_f32 v50, v50, v50 row_mirror row_mask:0xf bank_mask:0xf
    v_add_f32 v114, v114, v114 row_mirror row_mask:0xf bank_mask:0xf
    s_nop 0
    s_nop 0
    v_add_f32 v48, v48, v48 row_bcast:15 row_mask:0xa bank_mask:0xf
    v_add_f32 v112, v112, v112 row_bcast:15 row_mask:0xa bank_mask:0xf
    s_add_u32 m0, s8, 90112
    s_add_u32 s39, s9, 860160
    buffer_load_dwordx4 v6, s[52:55], s39 offen lds
    v_add_f32 v50, v50, v50 row_bcast:15 row_mask:0xa bank_mask:0xf
    v_add_f32 v114, v114, v114 row_bcast:15 row_mask:0xa bank_mask:0xf
    s_nop 0
    s_nop 0
    v_add_f32 v48, v48, v48 row_bcast:31 row_mask:0xc bank_mask:0xf
    v_add_f32 v112, v112, v112 row_bcast:31 row_mask:0xc bank_mask:0xf
    v_add_f32 v50, v50, v50 row_bcast:31 row_mask:0xc bank_mask:0xf
    v_add_f32 v114, v114, v114 row_bcast:31 row_mask:0xc bank_mask:0xf
    s_nop 0
    s_nop 0
    v_readlane_b32 s94, v48, 63
    v_readlane_b32 s14, v112, 63
    s_add_u32 m0, s8, 94208
    s_add_u32 s39, s9, 860160
    buffer_load_dwordx4 v6, s[56:59], s39 offen lds
    v_readlane_b32 s95, v50, 63
    v_readlane_b32 s15, v114, 63
    s_nop 1
    s_nop 1
    v_mov_b32 v53, 0x3b124925
    v_mov_b32 v117, 0x3b124925
    v_mul_f32 v52, s94, v53
    v_mul_f32 v116, s14, v117
    v_mul_f32 v54, s95, v53
    v_mul_f32 v118, s15, v117
    v_fma_f32 v54, -v52, v52, v54
    v_fma_f32 v118, -v116, v116, v118
    s_add_u32 m0, s8, 98304
    s_add_u32 s39, s9, 917504
    buffer_load_dwordx4 v6, s[52:55], s39 offen lds
    v_add_f32 v52, s92, v52
    v_add_f32 v116, s12, v116
    v_max_f32 v54, 0, v54
    v_max_f32 v118, 0, v118
    v_cvt_pk_bf16_f32 v53, v52, v54
    v_cvt_pk_bf16_f32 v117, v116, v118
    v_lshlrev_b32 v52, 16, v53
    v_lshlrev_b32 v116, 16, v117
    v_and_b32 v54, 0xffff0000, v53
    v_and_b32 v118, 0xffff0000, v117
    v_add_f32 v54, 0x3727c5ac, v54
    v_add_f32 v118, 0x3727c5ac, v118
    s_add_u32 m0, s8, 102400
    s_add_u32 s39, s9, 917504
    buffer_load_dwordx4 v6, s[56:59], s39 offen lds
    v_cvt_pk_bf16_f32 v54, v54, v54
    v_cvt_pk_bf16_f32 v118, v118, v118
    v_lshlrev_b32 v54, 16, v54
    v_lshlrev_b32 v118, 16, v118
    v_sqrt_f32 v54, v54
    v_sqrt_f32 v118, v118
    v_pk_add_f32 v[24:25], v[16:17], v[52:53] op_sel_hi:[1,0] neg_lo:[0,1] neg_hi:[0,1]
    v_pk_add_f32 v[88:89], v[80:81], v[116:117] op_sel_hi:[1,0] neg_lo:[0,1] neg_hi:[0,1]
    v_pk_add_f32 v[26:27], v[18:19], v[52:53] op_sel_hi:[1,0] neg_lo:[0,1] neg_hi:[0,1]
    v_pk_add_f32 v[90:91], v[82:83], v[116:117] op_sel_hi:[1,0] neg_lo:[0,1] neg_hi:[0,1]
    v_pk_add_f32 v[28:29], v[20:21], v[52:53] op_sel_hi:[1,0] neg_lo:[0,1] neg_hi:[0,1]
    v_pk_add_f32 v[92:93], v[84:85], v[116:117] op_sel_hi:[1,0] neg_lo:[0,1] neg_hi:[0,1]
    s_add_u32 m0, s8, 106496
    s_add_u32 s39, s9, 974848
    buffer_load_dwordx4 v6, s[52:55], s39 offen lds
    v_pk_add_f32 v[30:31], v[22:23], v[52:53] op_sel_hi:[1,0] neg_lo:[0,1] neg_hi:[0,1]
    v_pk_add_f32 v[94:95], v[86:87], v[116:117] op_sel_hi:[1,0] neg_lo:[0,1] neg_hi:[0,1]
    v_cvt_pk_bf16_f32 v54, v54, v54
    v_cvt_pk_bf16_f32 v118, v118, v118
    v_lshlrev_b32 v54, 16, v54
    v_lshlrev_b32 v118, 16, v118
    v_rcp_f32 v54, v54
    v_rcp_f32 v118, v118
    v_cvt_pk_bf16_f32 v48, v24, v25
    v_cvt_pk_bf16_f32 v112, v88, v89
    v_cvt_pk_bf16_f32 v49, v26, v27
    v_cvt_pk_bf16_f32 v113, v90, v91
    s_add_u32 m0, s8, 110592
    s_add_u32 s39, s9, 974848
    buffer_load_dwordx4 v6, s[56:59], s39 offen lds
    v_cvt_pk_bf16_f32 v50, v28, v29
    v_cvt_pk_bf16_f32 v114, v92, v93
    v_cvt_pk_bf16_f32 v51, v30, v31
    v_cvt_pk_bf16_f32 v115, v94, v95
    v_lshlrev_b32 v24, 16, v48
    v_lshlrev_b32 v88, 16, v112
    v_and_b32 v25, 0xffff0000, v48
    v_and_b32 v89, 0xffff0000, v112
    v_lshlrev_b32 v26, 16, v49
    v_lshlrev_b32 v90, 16, v113
    v_and_b32 v27, 0xffff0000, v49
    v_and_b32 v91, 0xffff0000, v113
    s_add_u32 m0, s8, 114688
    s_add_u32 s39, s9, 1032192
    buffer_load_dwordx4 v6, s[52:55], s39 offen lds
    v_lshlrev_b32 v28, 16, v50
    v_lshlrev_b32 v92, 16, v114
    v_and_b32 v29, 0xffff0000, v50
    v_and_b32 v93, 0xffff0000, v114
    v_lshlrev_b32 v30, 16, v51
    v_lshlrev_b32 v94, 16, v115
    v_and_b32 v31, 0xffff0000, v51
    v_and_b32 v95, 0xffff0000, v115
    v_pk_mul_f32 v[24:25], v[24:25], v[54:55] op_sel_hi:[1,0]
    v_pk_mul_f32 v[88:89], v[88:89], v[118:119] op_sel_hi:[1,0]
    v_pk_mul_f32 v[26:27], v[26:27], v[54:55] op_sel_hi:[1,0]
    v_pk_mul_f32 v[90:91], v[90:91], v[118:119] op_sel_hi:[1,0]
    s_add_u32 m0, s8, 118784
    s_add_u32 s39, s9, 1032192
    buffer_load_dwordx4 v6, s[56:59], s39 offen lds
    v_pk_mul_f32 v[28:29], v[28:29], v[54:55] op_sel_hi:[1,0]
    v_pk_mul_f32 v[92:93], v[92:93], v[118:119] op_sel_hi:[1,0]
    v_pk_mul_f32 v[30:31], v[30:31], v[54:55] op_sel_hi:[1,0]
    v_pk_mul_f32 v[94:95], v[94:95], v[118:119] op_sel_hi:[1,0]
    v_cvt_pk_bf16_f32 v48, v24, v25
    v_cvt_pk_bf16_f32 v112, v88, v89
    v_cvt_pk_bf16_f32 v49, v26, v27
    v_cvt_pk_bf16_f32 v113, v90, v91
    v_cvt_pk_bf16_f32 v50, v28, v29
    v_cvt_pk_bf16_f32 v114, v92, v93
    v_cvt_pk_bf16_f32 v51, v30, v31
    v_cvt_pk_bf16_f32 v115, v94, v95
    s_add_u32 m0, s8, 122880
    s_add_u32 s39, s9, 1089536
    buffer_load_dwordx4 v6, s[52:55], s39 offen lds
    v_lshlrev_b32 v24, 16, v48
    v_lshlrev_b32 v88, 16, v112
    v_and_b32 v25, 0xffff0000, v48
    v_and_b32 v89, 0xffff0000, v112
    v_lshlrev_b32 v26, 16, v49
    v_lshlrev_b32 v90, 16, v113
    v_and_b32 v27, 0xffff0000, v49
    v_and_b32 v91, 0xffff0000, v113
    v_lshlrev_b32 v28, 16, v50
    v_lshlrev_b32 v92, 16, v114
    v_and_b32 v29, 0xffff0000, v50
    v_and_b32 v93, 0xffff0000, v114
    s_add_u32 m0, s8, 126976
    s_add_u32 s39, s9, 1089536
    buffer_load_dwordx4 v6, s[56:59], s39 offen lds
    v_lshlrev_b32 v30, 16, v51
    v_lshlrev_b32 v94, 16, v115
    v_and_b32 v31, 0xffff0000, v51
    v_and_b32 v95, 0xffff0000, v115
    v_lshlrev_b32 v40, 16, v216
    v_lshlrev_b32 v104, 16, v216
    v_and_b32 v41, 0xffff0000, v216
    v_and_b32 v105, 0xffff0000, v216
    v_lshlrev_b32 v42, 16, v217
    v_lshlrev_b32 v106, 16, v217
    v_and_b32 v43, 0xffff0000, v217
    v_and_b32 v107, 0xffff0000, v217
    v_lshlrev_b32 v44, 16, v218
    v_lshlrev_b32 v108, 16, v218
    v_and_b32 v45, 0xffff0000, v218
    v_and_b32 v109, 0xffff0000, v218
    v_lshlrev_b32 v46, 16, v219
    v_lshlrev_b32 v110, 16, v219
    v_and_b32 v47, 0xffff0000, v219
    v_and_b32 v111, 0xffff0000, v219
    v_pk_mul_f32 v[24:25], v[24:25], v[40:41]
    v_pk_mul_f32 v[88:89], v[88:89], v[104:105]
    v_pk_mul_f32 v[26:27], v[26:27], v[42:43]
    v_pk_mul_f32 v[90:91], v[90:91], v[106:107]
    v_pk_mul_f32 v[28:29], v[28:29], v[44:45]
    v_pk_mul_f32 v[92:93], v[92:93], v[108:109]
    v_pk_mul_f32 v[30:31], v[30:31], v[46:47]
    v_pk_mul_f32 v[94:95], v[94:95], v[110:111]
    v_lshlrev_b32 v40, 16, v220
    v_lshlrev_b32 v104, 16, v220
    v_and_b32 v41, 0xffff0000, v220
    v_and_b32 v105, 0xffff0000, v220
    v_lshlrev_b32 v42, 16, v221
    v_lshlrev_b32 v106, 16, v221
    v_and_b32 v43, 0xffff0000, v221
    v_and_b32 v107, 0xffff0000, v221
    v_lshlrev_b32 v44, 16, v222
    v_lshlrev_b32 v108, 16, v222
    v_and_b32 v45, 0xffff0000, v222
    v_and_b32 v109, 0xffff0000, v222
    v_lshlrev_b32 v46, 16, v223
    v_lshlrev_b32 v110, 16, v223
    v_and_b32 v47, 0xffff0000, v223
    v_and_b32 v111, 0xffff0000, v223
    v_cvt_pk_bf16_f32 v48, v24, v25
    v_cvt_pk_bf16_f32 v112, v88, v89
    v_cvt_pk_bf16_f32 v49, v26, v27
    v_cvt_pk_bf16_f32 v113, v90, v91
    v_cvt_pk_bf16_f32 v50, v28, v29
    v_cvt_pk_bf16_f32 v114, v92, v93
    v_cvt_pk_bf16_f32 v51, v30, v31
    v_cvt_pk_bf16_f32 v115, v94, v95
    v_lshlrev_b32 v24, 16, v48
    v_lshlrev_b32 v88, 16, v112
    v_and_b32 v25, 0xffff0000, v48
    v_and_b32 v89, 0xffff0000, v112
    v_lshlrev_b32 v26, 16, v49
    v_lshlrev_b32 v90, 16, v113
    v_and_b32 v27, 0xffff0000, v49
    v_and_b32 v91, 0xffff0000, v113
    v_lshlrev_b32 v28, 16, v50
    v_lshlrev_b32 v92, 16, v114
    v_and_b32 v29, 0xffff0000, v50
    v_and_b32 v93, 0xffff0000, v114
    v_lshlrev_b32 v30, 16, v51
    v_lshlrev_b32 v94, 16, v115
    v_and_b32 v31, 0xffff0000, v51
    v_and_b32 v95, 0xffff0000, v115
    v_pk_add_f32 v[24:25], v[24:25], v[40:41]
    v_pk_add_f32 v[88:89], v[88:89], v[104:105]
    v_pk_add_f32 v[26:27], v[26:27], v[42:43]
    v_pk_add_f32 v[90:91], v[90:91], v[106:107]
    v_pk_add_f32 v[28:29], v[28:29], v[44:45]
    v_pk_add_f32 v[92:93], v[92:93], v[108:109]
    v_pk_add_f32 v[30:31], v[30:31], v[46:47]
    v_pk_add_f32 v[94:95], v[94:95], v[110:111]
    v_cvt_pk_bf16_f32 v48, v24, v25
    v_cvt_pk_bf16_f32 v112, v88, v89
    v_cvt_pk_bf16_f32 v49, v26, v27
    v_cvt_pk_bf16_f32 v113, v90, v91
    v_cvt_pk_bf16_f32 v50, v28, v29
    v_cvt_pk_bf16_f32 v114, v92, v93
    v_cvt_pk_bf16_f32 v51, v30, v31
    v_cvt_pk_bf16_f32 v115, v94, v95
    v_lshlrev_b32 v24, 16, v48
    v_lshlrev_b32 v88, 16, v112
    v_and_b32 v25, 0xffff0000, v48
    v_and_b32 v89, 0xffff0000, v112
    v_lshlrev_b32 v26, 16, v49
    v_lshlrev_b32 v90, 16, v113
    v_and_b32 v27, 0xffff0000, v49
    v_and_b32 v91, 0xffff0000, v113
    v_lshlrev_b32 v28, 16, v50
    v_lshlrev_b32 v92, 16, v114
    v_and_b32 v29, 0xffff0000, v50
    v_and_b32 v93, 0xffff0000, v114
    v_lshlrev_b32 v30, 16, v51
    v_lshlrev_b32 v94, 16, v115
    v_and_b32 v31, 0xffff0000, v51
    v_and_b32 v95, 0xffff0000, v115
    s_cmp_lg_u32 s32, 0
    s_cbranch_scc1 Ls0_12
    s_lshl_b32 s3, s33, 10
    v_add_u32 v8, s3, v5
    s_mov_b32 s3, 0
Lslp_13:
    buffer_load_dwordx4 v[12:15], v8, s[40:43], 0 offen sc1
    s_waitcnt vmcnt(0)
    v_min_u32 v12, v12, v13
    v_min3_u32 v12, v12, v14, v15
    v_cmp_gt_u32 vcc, s11, v12
    s_cbranch_vccz Lsdn_14
    s_sleep 1
    s_add_u32 s3, s3, 1
    s_cmp_lt_u32 s3, 200000
    s_cbranch_scc1 Lslp_13
Lsdn_14:
Ls0_12:
    s_barrier
    s_lshr_b32 s92, s100, 6
    s_mul_i32 s92, s92, 57344
    s_lshl_b32 s93, s35, 4
    s_add_u32 s92, s92, s93
    v_lshlrev_b32 v8, 7, v0
    v_add_u32 v8, s92, v8
    s_add_u32 s44, s30, 2097152
    s_addc_u32 s45, s31, 0
    s_mov_b32 s46, 1835008
    s_mov_b32 s47, 0x00020000
    s_mov_b32 s93, 32768
    buffer_load_dwordx4 v[144:147], v8, s[44:47], 0 offen sc1
    buffer_load_dwordx4 v[148:151], v8, s[44:47], s93 offen sc1
    s_add_u32 s44, s30, 5242880
    s_addc_u32 s45, s31, 0
    s_mov_b32 s46, 1835008
    s_mov_b32 s47, 0x00020000
    s_add_u32 s48, s30, 7340032
    s_addc_u32 s49, s31, 0
    s_mov_b32 s50, 1835008
    s_mov_b32 s51, 0x00020000
    v_lshlrev_b32 v8, 1, v0
    s_mul_i32 s92, s32, 1824
    v_add_u32 v9, s92, v5
    v_and_b32 v10, 7, v0
    v_lshrrev_b32 v11, 3, v0
    v_mul_u32_u24 v12, 912, v10
    v_lshl_add_u32 v12, v11, 4, v12
    s_lshr_b32 s92, s100, 5
    s_mul_i32 s92, s92, 28672
    s_and_b32 s93, s100, 31
    s_lshl_b32 s93, s93, 4
    s_add_u32 s92, s92, s93
    v_lshlrev_b32 v11, 9, v11
    v_lshl_add_u32 v11, v10, 4, v11
    v_add_u32 v11, s92, v11
    s_waitcnt vmcnt(0)
    ds_write_b16 v8, v144 offset:0
    ds_write_b16_d16_hi v8, v144 offset:912
    ds_write_b16 v8, v145 offset:1824
    ds_write_b16_d16_hi v8, v145 offset:2736
    ds_write_b16 v8, v146 offset:3648
    ds_write_b16_d16_hi v8, v146 offset:4560
    ds_write_b16 v8, v147 offset:5472
    ds_write_b16_d16_hi v8, v147 offset:6384
    s_cmp_eq_u32 s32, 3
    s_cbranch_scc1 Lys_15
    ds_write_b16 v8, v148 offset:512
    ds_write_b16_d16_hi v8, v148 offset:1424
    ds_write_b16 v8, v149 offset:2336
    ds_write_b16_d16_hi v8, v149 offset:3248
    ds_write_b16 v8, v150 offset:4160
    ds_write_b16_d16_hi v8, v150 offset:5072
    ds_write_b16 v8, v151 offset:5984
    ds_write_b16_d16_hi v8, v151 offset:6896
Lys_15:
    s_waitcnt lgkmcnt(0)
    s_barrier
    ds_read_b128 v[64:67], v9 offset:0
    ds_read_b128 v[128:131], v9 offset:912
    s_waitcnt lgkmcnt(0)
    v_lshlrev_b32 v40, 16, v64
    v_lshlrev_b32 v104, 16, v128
    v_and_b32 v41, 0xffff0000, v64
    v_and_b32 v105, 0xffff0000, v128
    v_lshlrev_b32 v42, 16, v65
    v_lshlrev_b32 v106, 16, v129
    v_and_b32 v43, 0xffff0000, v65
    v_and_b32 v107, 0xffff0000, v129
    v_lshlrev_b32 v44, 16, v66
    v_lshlrev_b32 v108, 16, v130
    v_and_b32 v45, 0xffff0000, v66
    v_and_b32 v109, 0xffff0000, v130
    v_lshlrev_b32 v46, 16, v67
    v_lshlrev_b32 v110, 16, v131
    v_and_b32 v47, 0xffff0000, v67
    v_and_b32 v111, 0xffff0000, v131
    v_pk_mul_f32 v[24:25], v[24:25], v[40:41]
    v_pk_mul_f32 v[88:89], v[88:89], v[104:105]
    v_pk_mul_f32 v[26:27], v[26:27], v[42:43]
    v_pk_mul_f32 v[90:91], v[90:91], v[106:107]
    s_add_u32 m0, s8, 131072
    s_add_u32 s39, s9, 1146880
    buffer_load_dwordx4 v6, s[52:55], s39 offen lds
    v_pk_mul_f32 v[28:29], v[28:29], v[44:45]
    v_pk_mul_f32 v[92:93], v[92:93], v[108:109]
    v_pk_mul_f32 v[30:31], v[30:31], v[46:47]
    v_pk_mul_f32 v[94:95], v[94:95], v[110:111]
    v_lshlrev_b32 v40, 16, v224
    v_lshlrev_b32 v104, 16, v224
    v_and_b32 v41, 0xffff0000, v224
    v_and_b32 v105, 0xffff0000, v224
    v_lshlrev_b32 v42, 16, v225
    v_lshlrev_b32 v106, 16, v225
    v_and_b32 v43, 0xffff0000, v225
    v_and_b32 v107, 0xffff0000, v225
    v_lshlrev_b32 v44, 16, v226
    v_lshlrev_b32 v108, 16, v226
    v_and_b32 v45, 0xffff0000, v226
    v_and_b32 v109, 0xffff0000, v226
    v_lshlrev_b32 v46, 16, v227
    v_lshlrev_b32 v110, 16, v227
    v_and_b32 v47, 0xffff0000, v227
    v_and_b32 v111, 0xffff0000, v227
    s_add_u32 m0, s8, 135168
    s_add_u32 s39, s9, 1146880
    buffer_load_dwordx4 v6, s[56:59], s39 offen lds
    v_cvt_pk_bf16_f32 v48, v24, v25
    v_cvt_pk_bf16_f32 v112, v88, v89
    v_cvt_pk_bf16_f32 v49, v26, v27
    v_cvt_pk_bf16_f32 v113, v90, v91
    v_cvt_pk_bf16_f32 v50, v28, v29
    v_cvt_pk_bf16_f32 v114, v92, v93
    v_cvt_pk_bf16_f32 v51, v30, v31
    v_cvt_pk_bf16_f32 v115, v94, v95
    v_lshlrev_b32 v24, 16, v48
    v_lshlrev_b32 v88, 16, v112
    v_and_b32 v25, 0xffff0000, v48
    v_and_b32 v89, 0xffff0000, v112
    v_lshlrev_b32 v26, 16, v49
    v_lshlrev_b32 v90, 16, v113
    v_and_b32 v27, 0xffff0000, v49
    v_and_b32 v91, 0xffff0000, v113
    v_lshlrev_b32 v28, 16, v50
    v_lshlrev_b32 v92, 16, v114
    v_and_b32 v29, 0xffff0000, v50
    v_and_b32 v93, 0xffff0000, v114
    s_add_u32 m0, s8, 139264
    s_add_u32 s39, s9, 1204224
    buffer_load_dwordx4 v6, s[52:55], s39 offen lds
    v_lshlrev_b32 v30, 16, v51
    v_lshlrev_b32 v94, 16, v115
    v_and_b32 v31, 0xffff0000, v51
    v_and_b32 v95, 0xffff0000, v115
    v_pk_mul_f32 v[24:25], v[24:25], v[40:41]
    v_pk_mul_f32 v[88:89], v[88:89], v[104:105]
    v_pk_mul_f32 v[26:27], v[26:27], v[42:43]
    v_pk_mul_f32 v[90:91], v[90:91], v[106:107]
    v_pk_mul_f32 v[28:29], v[28:29], v[44:45]
    v_pk_mul_f32 v[92:93], v[92:93], v[108:109]
    v_pk_mul_f32 v[30:31], v[30:31], v[46:47]
    v_pk_mul_f32 v[94:95], v[94:95], v[110:111]
    v_cvt_pk_bf16_f32 v48, v24, v25
    v_cvt_pk_bf16_f32 v112, v88, v89
    v_cvt_pk_bf16_f32 v49, v26, v27
    v_cvt_pk_bf16_f32 v113, v90, v91
    v_cvt_pk_bf16_f32 v50, v28, v29
    v_cvt_pk_bf16_f32 v114, v92, v93
    v_cvt_pk_bf16_f32 v51, v30, v31
    v_cvt_pk_bf16_f32 v115, v94, v95
    s_add_u32 m0, s8, 143360
    s_add_u32 s39, s9, 1204224
    buffer_load_dwordx4 v6, s[56:59], s39 offen lds
    v_lshlrev_b32 v24, 16, v48
    v_lshlrev_b32 v88, 16, v112
    v_and_b32 v25, 0xffff0000, v48
    v_and_b32 v89, 0xffff0000, v112
    v_lshlrev_b32 v26, 16, v49
    v_lshlrev_b32 v90, 16, v113
    v_and_b32 v27, 0xffff0000, v49
    v_and_b32 v91, 0xffff0000, v113
    v_lshlrev_b32 v28, 16, v50
    v_lshlrev_b32 v92, 16, v114
    v_and_b32 v29, 0xffff0000, v50
    v_and_b32 v93, 0xffff0000, v114
    v_lshlrev_b32 v30, 16, v51
    v_lshlrev_b32 v94, 16, v115
    v_and_b32 v31, 0xffff0000, v51
    v_and_b32 v95, 0xffff0000, v115
    v_pk_add_f32 v[16:17], v[16:17], v[24:25]
    v_pk_add_f32 v[80:81], v[80:81], v[88:89]
    v_pk_add_f32 v[18:19], v[18:19], v[26:27]
    v_pk_add_f32 v[82:83], v[82:83], v[90:91]
    s_add_u32 m0, s8, 147456
    s_add_u32 s39, s9, 1261568
    buffer_load_dwordx4 v6, s[52:55], s39 offen lds
    v_pk_add_f32 v[20:21], v[20:21], v[28:29]
    v_pk_add_f32 v[84:85], v[84:85], v[92:93]
    v_pk_add_f32 v[22:23], v[22:23], v[30:31]
    v_pk_add_f32 v[86:87], v[86:87], v[94:95]
    v_cvt_pk_bf16_f32 v56, v16, v17
    v_cvt_pk_bf16_f32 v120, v80, v81
    v_cvt_pk_bf16_f32 v57, v18, v19
    v_cvt_pk_bf16_f32 v121, v82, v83
    v_cvt_pk_bf16_f32 v58, v20, v21
    v_cvt_pk_bf16_f32 v122, v84, v85
    v_cvt_pk_bf16_f32 v59, v22, v23
    v_cvt_pk_bf16_f32 v123, v86, v87
    v_lshlrev_b32 v16, 16, v56
    v_lshlrev_b32 v80, 16, v120
    v_and_b32 v17, 0xffff0000, v56
    v_and_b32 v81, 0xffff0000, v120
    v_lshlrev_b32 v18, 16, v57
    v_lshlrev_b32 v82, 16, v121
    v_and_b32 v19, 0xffff0000, v57
    v_and_b32 v83, 0xffff0000, v121
    s_add_u32 m0, s8, 151552
    s_add_u32 s39, s9, 1261568
    buffer_load_dwordx4 v6, s[56:59], s39 offen lds
    v_lshlrev_b32 v20, 16, v58
    v_lshlrev_b32 v84, 16, v122
    v_and_b32 v21, 0xffff0000, v58
    v_and_b32 v85, 0xffff0000, v122
    v_lshlrev_b32 v22, 16, v59
    v_lshlrev_b32 v86, 16, v123
    v_and_b32 v23, 0xffff0000, v59
    v_and_b32 v87, 0xffff0000, v123
    s_nop 0
    s_nop 0
    v_readlane_b32 s92, v16, 0
    v_readlane_b32 s12, v80, 0
    s_nop 0
    s_nop 0
    s_mov_b32 s93, s92
    s_mov_b32 s13, s12
    s_nop 1
    s_nop 1
    v_pk_add_f32 v[32:33], v[16:17], s[92:93] neg_lo:[0,1] neg_hi:[0,1]
    v_pk_add_f32 v[96:97], v[80:81], s[12:13] neg_lo:[0,1] neg_hi:[0,1]
    s_add_u32 m0, s8, 155648
    s_add_u32 s39, s9, 1318912
    buffer_load_dwordx4 v6, s[52:55], s39 offen lds
    v_pk_add_f32 v[34:35], v[18:19], s[92:93] neg_lo:[0,1] neg_hi:[0,1]
    v_pk_add_f32 v[98:99], v[82:83], s[12:13] neg_lo:[0,1] neg_hi:[0,1]
    v_pk_add_f32 v[36:37], v[20:21], s[92:93] neg_lo:[0,1] neg_hi:[0,1]
    v_pk_add_f32 v[100:101], v[84:85], s[12:13] neg_lo:[0,1] neg_hi:[0,1]
    v_pk_add_f32 v[38:39], v[22:23], s[92:93] neg_lo:[0,1] neg_hi:[0,1]
    v_pk_add_f32 v[102:103], v[86:87], s[12:13] neg_lo:[0,1] neg_hi:[0,1]
    v_pk_mul_f32 v[50:51], v[32:33], v[32:33]
    v_pk_mul_f32 v[114:115], v[96:97], v[96:97]
    v_pk_add_f32 v[48:49], v[32:33], v[34:35]
    v_pk_add_f32 v[112:113], v[96:97], v[98:99]
    v_pk_fma_f32 v[50:51], v[34:35], v[34:35], v[50:51]
    v_pk_fma_f32 v[114:115], v[98:99], v[98:99], v[114:115]
    v_pk_add_f32 v[48:49], v[48:49], v[36:37]
    v_pk_add_f32 v[112:113], v[112:113], v[100:101]
    v_pk_fma_f32 v[50:51], v[36:37], v[36:37], v[50:51]
    v_pk_fma_f32 v[114:115], v[100:101], v[100:101], v[114:115]
    v_pk_add_f32 v[48:49], v[48:49], v[38:39]
    v_pk_add_f32 v[112:113], v[112:113], v[102:103]
    v_pk_fma_f32 v[50:51], v[38:39], v[38:39], v[50:51]
    v_pk_fma_f32 v[114:115], v[102:103], v[102:103], v[114:115]
    s_add_u32 m0, s8, 159744
    s_add_u32 s39, s9, 1318912
    buffer_load_dwordx4 v6, s[56:59], s39 offen lds
    v_add_f32 v48, v48, v49
    v_add_f32 v112, v112, v113
    v_add_f32 v50, v50, v51
    v_add_f32 v114, v114, v115
    v_cndmask_b32 v48, 0, v48, s[6:7]
    v_cndmask_b32 v112, 0, v112, s[6:7]
    v_cndmask_b32 v50, 0, v50, s[6:7]
    v_cndmask_b32 v114, 0, v114, s[6:7]
    s_nop 1
    s_nop 1
    v_add_f32 v48, v48, v48 quad_perm:[1,0,3,2] row_mask:0xf bank_mask:0xf
    v_add_f32 v112, v112, v112 quad_perm:[1,0,3,2] row_mask:0xf bank_mask:0xf
    v_add_f32 v50, v50, v50 quad_perm:[1,0,3,2] row_mask:0xf bank_mask:0xf
    v_add_f32 v114, v114, v114 quad_perm:[1,0,3,2] row_mask:0xf bank_mask:0xf
    s_nop 0
    s_nop 0
    v_add_f32 v48, v48, v48 quad_perm:[2,3,0,1] row_mask:0xf bank_mask:0xf
    v_add_f32 v112, v112, v112 quad_perm:[2,3,0,1] row_mask:0xf bank_mask:0xf
    v_add_f32 v50, v50, v50 quad_perm:[2,3,0,1] row_mask:0xf bank_mask:0xf
    v_add_f32 v114, v114, v114 quad_perm:[2,3,0,1] row_mask:0xf bank_mask:0xf
    s_nop 0
    s_nop 0
    v_add_f32 v48, v48, v48 row_half_mirror row_mask:0xf bank_mask:0xf
    v_add_f32 v112, v112, v112 row_half_mirror row_mask:0xf bank_mask:0xf
    v_add_f32 v50, v50, v50 row_half_mirror row_mask:0xf bank_mask:0xf
    v_add_f32 v114, v114, v114 row_half_mirror row_mask:0xf bank_mask:0xf
    s_nop 0
    s_nop 0
    v_add_f32 v48, v48, v48 row_mirror row_mask:0xf bank_mask:0xf
    v_add_f32 v112, v112, v112 row_mirror row_mask:0xf bank_mask:0xf
    v_add_f32 v50, v50, v50 row_mirror row_mask:0xf bank_mask:0xf
    v_add_f32 v114, v114, v114 row_mirror row_mask:0xf bank_mask:0xf
    s_nop 0
    s_nop 0
    v_add_f32 v48, v48, v48 row_bcast:15 row_mask:0xa bank_mask:0xf
    v_add_f32 v112, v112, v112 row_bcast:15 row_mask:0xa bank_mask:0xf
    v_add_f32 v50, v50, v50 row_bcast:15 row_mask:0xa bank_mask:0xf
    v_add_f32 v114, v114, v114 row_bcast:15 row_mask:0xa bank_mask:0xf
    s_nop 0
    s_nop 0
    v_add_f32 v48, v48, v48 row_bcast:31 row_mask:0xc bank_mask:0xf
    v_add_f32 v112, v112, v112 row_bcast:31 row_mask:0xc bank_mask:0xf
    v_add_f32 v50, v50, v50 row_bcast:31 row_mask:0xc bank_mask:0xf
    v_add_f32 v114, v114, v114 row_bcast:31 row_mask:0xc bank_mask:0xf
    s_nop 0
    s_nop 0
    v_readlane_b32 s94, v48, 63
    v_readlane_b32 s14, v112, 63
    v_readlane_b32 s95, v50, 63
    v_readlane_b32 s15, v114, 63
    s_nop 1
    s_nop 1
    v_mov_b32 v53, 0x3b124925
    v_mov_b32 v117, 0x3b124925
    v_mul_f32 v52, s94, v53
    v_mul_f32 v116, s14, v117
    v_mul_f32 v54, s95, v53
    v_mul_f32 v118, s15, v117
    v_fma_f32 v54, -v52, v52, v54
    v_fma_f32 v118, -v116, v116, v118
    v_add_f32 v52, s92, v52
    v_add_f32 v116, s12, v116
    v_max_f32 v54, 0, v54
    v_max_f32 v118, 0, v118
    v_cvt_pk_bf16_f32 v53, v52, v54
    v_cvt_pk_bf16_f32 v117, v116, v118
    v_lshlrev_b32 v52, 16, v53
    v_lshlrev_b32 v116, 16, v117
    v_and_b32 v54, 0xffff0000, v53
    v_and_b32 v118, 0xffff0000, v117
    v_add_f32 v54, 0x3727c5ac, v54
    v_add_f32 v118, 0x3727c5ac, v118
    v_cvt_pk_bf16_f32 v54, v54, v54
    v_cvt_pk_bf16_f32 v118, v118, v118
    v_lshlrev_b32 v54, 16, v54
    v_lshlrev_b32 v118, 16, v118
    v_sqrt_f32 v54, v54
    v_sqrt_f32 v118, v118
    v_pk_add_f32 v[24:25], v[16:17], v[52:53] op_sel_hi:[1,0] neg_lo:[0,1] neg_hi:[0,1]
    v_pk_add_f32 v[88:89], v[80:81], v[116:117] op_sel_hi:[1,0] neg_lo:[0,1] neg_hi:[0,1]
    v_pk_add_f32 v[26:27], v[18:19], v[52:53] op_sel_hi:[1,0] neg_lo:[0,1] neg_hi:[0,1]
    v_pk_add_f32 v[90:91], v[82:83], v[116:117] op_sel_hi:[1,0] neg_lo:[0,1] neg_hi:[0,1]
    v_pk_add_f32 v[28:29], v[20:21], v[52:53] op_sel_hi:[1,0] neg_lo:[0,1] neg_hi:[0,1]
    v_pk_add_f32 v[92:93], v[84:85], v[116:117] op_sel_hi:[1,0] neg_lo:[0,1] neg_hi:[0,1]
    v_pk_add_f32 v[30:31], v[22:23], v[52:53] op_sel_hi:[1,0] neg_lo:[0,1] neg_hi:[0,1]
    v_pk_add_f32 v[94:95], v[86:87], v[116:117] op_sel_hi:[1,0] neg_lo:[0,1] neg_hi:[0,1]
    v_cvt_pk_bf16_f32 v54, v54, v54
    v_cvt_pk_bf16_f32 v118, v118, v118
    v_lshlrev_b32 v54, 16, v54
    v_lshlrev_b32 v118, 16, v118
    v_rcp_f32 v54, v54
    v_rcp_f32 v118, v118
    v_cvt_pk_bf16_f32 v48, v24, v25
    v_cvt_pk_bf16_f32 v112, v88, v89
    v_cvt_pk_bf16_f32 v49, v26, v27
    v_cvt_pk_bf16_f32 v113, v90, v91
    v_cvt_pk_bf16_f32 v50, v28, v29
    v_cvt_pk_bf16_f32 v114, v92, v93
    v_cvt_pk_bf16_f32 v51, v30, v31
    v_cvt_pk_bf16_f32 v115, v94, v95
    v_lshlrev_b32 v24, 16, v48
    v_lshlrev_b32 v88, 16, v112
    v_and_b32 v25, 0xffff0000, v48
    v_and_b32 v89, 0xffff0000, v112
    v_lshlrev_b32 v26, 16, v49
    v_lshlrev_b32 v90, 16, v113
    v_and_b32 v27, 0xffff0000, v49
    v_and_b32 v91, 0xffff0000, v113
    v_lshlrev_b32 v28, 16, v50
    v_lshlrev_b32 v92, 16, v114
    v_and_b32 v29, 0xffff0000, v50
    v_and_b32 v93, 0xffff0000, v114
    v_lshlrev_b32 v30, 16, v51
    v_lshlrev_b32 v94, 16, v115
    v_and_b32 v31, 0xffff0000, v51
    v_and_b32 v95, 0xffff0000, v115
    v_pk_mul_f32 v[24:25], v[24:25], v[54:55] op_sel_hi:[1,0]
    v_pk_mul_f32 v[88:89], v[88:89], v[118:119] op_sel_hi:[1,0]
    v_pk_mul_f32 v[26:27], v[26:27], v[54:55] op_sel_hi:[1,0]
    v_pk_mul_f32 v[90:91], v[90:91], v[118:119] op_sel_hi:[1,0]
    v_pk_mul_f32 v[28:29], v[28:29], v[54:55] op_sel_hi:[1,0]
    v_pk_mul_f32 v[92:93], v[92:93], v[118:119] op_sel_hi:[1,0]
    v_pk_mul_f32 v[30:31], v[30:31], v[54:55] op_sel_hi:[1,0]
    v_pk_mul_f32 v[94:95], v[94:95], v[118:119] op_sel_hi:[1,0]
    v_cvt_pk_bf16_f32 v48, v24, v25
    v_cvt_pk_bf16_f32 v112, v88, v89
    v_cvt_pk_bf16_f32 v49, v26, v27
    v_cvt_pk_bf16_f32 v113, v90, v91
    v_cvt_pk_bf16_f32 v50, v28, v29
    v_cvt_pk_bf16_f32 v114, v92, v93
    v_cvt_pk_bf16_f32 v51, v30, v31
    v_cvt_pk_bf16_f32 v115, v94, v95
    v_lshlrev_b32 v24, 16, v48
    v_lshlrev_b32 v88, 16, v112
    v_and_b32 v25, 0xffff0000, v48
    v_and_b32 v89, 0xffff0000, v112
    v_lshlrev_b32 v26, 16, v49
    v_lshlrev_b32 v90, 16, v113
    v_and_b32 v27, 0xffff0000, v49
    v_and_b32 v91, 0xffff0000, v113
    v_lshlrev_b32 v28, 16, v50
    v_lshlrev_b32 v92, 16, v114
    v_and_b32 v29, 0xffff0000, v50
    v_and_b32 v93, 0xffff0000, v114
    v_lshlrev_b32 v30, 16, v51
    v_lshlrev_b32 v94, 16, v115
    v_and_b32 v31, 0xffff0000, v51
    v_and_b32 v95, 0xffff0000, v115
    v_lshlrev_b32 v40, 16, v228
    v_lshlrev_b32 v104, 16, v228
    v_and_b32 v41, 0xffff0000, v228
    v_and_b32 v105, 0xffff0000, v228
    v_lshlrev_b32 v42, 16, v229
    v_lshlrev_b32 v106, 16, v229
    v_and_b32 v43, 0xffff0000, v229
    v_and_b32 v107, 0xffff0000, v229
    v_lshlrev_b32 v44, 16, v230
    v_lshlrev_b32 v108, 16, v230
    v_and_b32 v45, 0xffff0000, v230
    v_and_b32 v109, 0xffff0000, v230
    v_lshlrev_b32 v46, 16, v231
    v_lshlrev_b32 v110, 16, v231
    v_and_b32 v47, 0xffff0000, v231
    v_and_b32 v111, 0xffff0000, v231
    v_pk_mul_f32 v[24:25], v[24:25], v[40:41]
    v_pk_mul_f32 v[88:89], v[88:89], v[104:105]
    v_pk_mul_f32 v[26:27], v[26:27], v[42:43]
    v_pk_mul_f32 v[90:91], v[90:91], v[106:107]
    v_pk_mul_f32 v[28:29], v[28:29], v[44:45]
    v_pk_mul_f32 v[92:93], v[92:93], v[108:109]
    v_pk_mul_f32 v[30:31], v[30:31], v[46:47]
    v_pk_mul_f32 v[94:95], v[94:95], v[110:111]
    v_lshlrev_b32 v40, 16, v232
    v_lshlrev_b32 v104, 16, v232
    v_and_b32 v41, 0xffff0000, v232
    v_and_b32 v105, 0xffff0000, v232
    v_lshlrev_b32 v42, 16, v233
    v_lshlrev_b32 v106, 16, v233
    v_and_b32 v43, 0xffff0000, v233
    v_and_b32 v107, 0xffff0000, v233
    v_lshlrev_b32 v44, 16, v234
    v_lshlrev_b32 v108, 16, v234
    v_and_b32 v45, 0xffff0000, v234
    v_and_b32 v109, 0xffff0000, v234
    v_lshlrev_b32 v46, 16, v235
    v_lshlrev_b32 v110, 16, v235
    v_and_b32 v47, 0xffff0000, v235
    v_and_b32 v111, 0xffff0000, v235
    v_cvt_pk_bf16_f32 v48, v24, v25
    v_cvt_pk_bf16_f32 v112, v88, v89
    v_cvt_pk_bf16_f32 v49, v26, v27
    v_cvt_pk_bf16_f32 v113, v90, v91
    v_cvt_pk_bf16_f32 v50, v28, v29
    v_cvt_pk_bf16_f32 v114, v92, v93
    v_cvt_pk_bf16_f32 v51, v30, v31
    v_cvt_pk_bf16_f32 v115, v94, v95
    v_lshlrev_b32 v24, 16, v48
    v_lshlrev_b32 v88, 16, v112
    v_and_b32 v25, 0xffff0000, v48
    v_and_b32 v89, 0xffff0000, v112
    v_lshlrev_b32 v26, 16, v49
    v_lshlrev_b32 v90, 16, v113
    v_and_b32 v27, 0xffff0000, v49
    v_and_b32 v91, 0xffff0000, v113
    v_lshlrev_b32 v28, 16, v50
    v_lshlrev_b32 v92, 16, v114
    v_and_b32 v29, 0xffff0000, v50
    v_and_b32 v93, 0xffff0000, v114
    v_lshlrev_b32 v30, 16, v51
    v_lshlrev_b32 v94, 16, v115
    v_and_b32 v31, 0xffff0000, v51
    v_and_b32 v95, 0xffff0000, v115
    v_pk_add_f32 v[24:25], v[24:25], v[40:41]
    v_pk_add_f32 v[88:89], v[88:89], v[104:105]
    v_pk_add_f32 v[26:27], v[26:27], v[42:43]
    v_pk_add_f32 v[90:91], v[90:91], v[106:107]
    v_pk_add_f32 v[28:29], v[28:29], v[44:45]
    v_pk_add_f32 v[92:93], v[92:93], v[108:109]
    v_pk_add_f32 v[30:31], v[30:31], v[46:47]
    v_pk_add_f32 v[94:95], v[94:95], v[110:111]
    v_cvt_pk_bf16_f32 v60, v24, v25
    v_cvt_pk_bf16_f32 v124, v88, v89
    v_cvt_pk_bf16_f32 v61, v26, v27
    v_cvt_pk_bf16_f32 v125, v90, v91
    v_cvt_pk_bf16_f32 v62, v28, v29
    v_cvt_pk_bf16_f32 v126, v92, v93
    v_cvt_pk_bf16_f32 v63, v30, v31
    v_cvt_pk_bf16_f32 v127, v94, v95
    s_lshl_b32 s3, s33, 8
    s_add_u32 s3, s3, 16384
    v_and_b32 v13, 31, v2
    v_add_u32 v13, s3, v13
    buffer_load_dword v152, v13, s[40:43], 0 offen sc1
    s_mov_b64 exec, s[6:7]
    ds_write_b128 v9, v[60:63] offset:0
    ds_write_b128 v9, v[124:127] offset:912
    buffer_store_dwordx4 v[56:59], v236, s[44:47], 0 offen offset:0 sc1
    buffer_store_dwordx4 v[120:123], v236, s[44:47], 0 offen offset:896 sc1
    s_mov_b64 exec, -1
    s_waitcnt lgkmcnt(0)
    s_barrier
    ds_read_b128 v[144:147], v12 offset:0
    ds_read_b128 v[148:151], v12 offset:512
    s_movk_i32 s92, 16384
    s_waitcnt lgkmcnt(1)
    buffer_store_dwordx4 v[144:147], v11, s[48:51], 0 offen sc1
    s_cmp_eq_u32 s32, 3
    s_cbranch_scc1 Lh2_16
    s_waitcnt lgkmcnt(0)
    buffer_store_dwordx4 v[148:151], v11, s[48:51], s92 offen sc1
Lh2_16:
    s_waitcnt vmcnt(3)
    v_cmp_gt_u32 vcc, 1, v152
    s_mov_b32 s101, 0
    s_cbranch_vccnz Lxa_17
    s_mov_b32 s101, 1
    s_waitcnt lgkmcnt(0)
    s_mul_i32 s12, s33, 57344
    s_mul_i32 s13, s32, 7168
    s_add_u32 s12, s12, s13
    s_add_u32 s44, s30, 7340032
    s_addc_u32 s45, s31, 0
    s_mov_b32 s46, 1835008
    s_mov_b32 s47, 0x00020000
    s_add_u32 m0, s13, 7296
    s_add_u32 s14, s12, 0
    buffer_load_dwordx4 v5, s[44:47], s14 offen sc1 lds
    s_add_u32 m0, s13, 8320
    s_add_u32 s14, s12, 1024
    buffer_load_dwordx4 v5, s[44:47], s14 offen sc1 lds
    s_add_u32 m0, s13, 9344
    s_add_u32 s14, s12, 2048
    buffer_load_dwordx4 v5, s[44:47], s14 offen sc1 lds
    s_add_u32 m0, s13, 10368
    s_add_u32 s14, s12, 3072
    buffer_load_dwordx4 v5, s[44:47], s14 offen sc1 lds
    s_add_u32 m0, s13, 11392
    s_add_u32 s14, s12, 4096
    buffer_load_dwordx4 v5, s[44:47], s14 offen sc1 lds
    s_add_u32 m0, s13, 12416
    s_add_u32 s14, s12, 5120
    buffer_load_dwordx4 v5, s[44:47], s14 offen sc1 lds
    s_add_u32 m0, s13, 13440
    s_add_u32 s14, s12, 6144
    buffer_load_dwordx4 v5, s[44:47], s14 offen sc1 lds
    s_add_u32 m0, s13, 35968
    s_add_u32 s14, s12, 28672
    buffer_load_dwordx4 v5, s[44:47], s14 offen sc1 lds
    s_add_u32 m0, s13, 36992
    s_add_u32 s14, s12, 29696
    buffer_load_dwordx4 v5, s[44:47], s14 offen sc1 lds
    s_add_u32 m0, s13, 38016
    s_add_u32 s14, s12, 30720
    buffer_load_dwordx4 v5, s[44:47], s14 offen sc1 lds
    s_add_u32 m0, s13, 39040
    s_add_u32 s14, s12, 31744
    buffer_load_dwordx4 v5, s[44:47], s14 offen sc1 lds
    s_add_u32 m0, s13, 40064
    s_add_u32 s14, s12, 32768
    buffer_load_dwordx4 v5, s[44:47], s14 offen sc1 lds
    s_add_u32 m0, s13, 41088
    s_add_u32 s14, s12, 33792
    buffer_load_dwordx4 v5, s[44:47], s14 offen sc1 lds
    s_add_u32 m0, s13, 42112
    s_add_u32 s14, s12, 34816
    buffer_load_dwordx4 v5, s[44:47], s14 offen sc1 lds
    s_waitcnt vmcnt(14)
    s_branch Lxb_18
Lxa_17:
    s_waitcnt vmcnt(0)
Lxb_18:
    s_waitcnt lgkmcnt(0)
    s_barrier
    s_cmp_lg_u32 s32, 0
    s_cbranch_scc1 Lpub_19
    v_mov_b32 v1, 1
    s_mov_b64 exec, 1
    s_add_u32 s3, s10, 0
    v_mov_b32 v15, s3
    buffer_store_dword v1, v15, s[40:43], 0 offen sc1
    s_mov_b64 exec, -1
Lpub_19:
    ds_read_b64_tr_b16 a[96:97], v7 offset:0
    ds_read_b64_tr_b16 a[98:99], v7 offset:1024
    ds_read_b64_tr_b16 a[100:101], v7 offset:4096
    ds_read_b64_tr_b16 a[102:103], v7 offset:5120
    ds_read_b64_tr_b16 a[104:105], v7 offset:8192
    ds_read_b64_tr_b16 a[106:107], v7 offset:9216
    ds_read_b64_tr_b16 a[108:109], v7 offset:12288
    ds_read_b64_tr_b16 a[110:111], v7 offset:13312
    ds_read_b64_tr_b16 a[112:113], v7 offset:16384
    ds_read_b64_tr_b16 a[114:115], v7 offset:17408
    ds_read_b64_tr_b16 a[116:117], v7 offset:20480
    ds_read_b64_tr_b16 a[118:119], v7 offset:21504
    ds_read_b64_tr_b16 a[120:121], v7 offset:24576
    ds_read_b64_tr_b16 a[122:123], v7 offset:25600
    ds_read_b64_tr_b16 a[124:125], v7 offset:28672
    ds_read_b64_tr_b16 a[126:127], v7 offset:29696
    ds_read_b64_tr_b16 a[128:129], v7 offset:32768
    ds_read_b64_tr_b16 a[130:131], v7 offset:33792
    ds_read_b64_tr_b16 a[132:133], v7 offset:36864
    ds_read_b64_tr_b16 a[134:135], v7 offset:37888
    ds_read_b64_tr_b16 a[136:137], v7 offset:40960
    ds_read_b64_tr_b16 a[138:139], v7 offset:41984
    ds_read_b64_tr_b16 a[140:141], v7 offset:45056
    ds_read_b64_tr_b16 a[142:143], v7 offset:46080
    ds_read_b64_tr_b16 a[144:145], v7 offset:49152
    ds_read_b64_tr_b16 a[146:147], v7 offset:50176
    ds_read_b64_tr_b16 a[148:149], v7 offset:53248
    ds_read_b64_tr_b16 a[150:151], v7 offset:54272
    ds_read_b64_tr_b16 a[152:153], v7 offset:57344
    ds_read_b64_tr_b16 a[154:155], v7 offset:58368
    ds_read_b64_tr_b16 a[156:157], v7 offset:61440
    ds_read_b64_tr_b16 a[158:159], v7 offset:62464
    ds_read_b64_tr_b16 a[160:161], v3 offset:16384
    ds_read_b64_tr_b16 a[162:163], v3 offset:17408
    ds_read_b64_tr_b16 a[164:165], v3 offset:20480
    ds_read_b64_tr_b16 a[166:167], v3 offset:21504
    ds_read_b64_tr_b16 a[168:169], v3 offset:24576
    ds_read_b64_tr_b16 a[170:171], v3 offset:25600
    ds_read_b64_tr_b16 a[172:173], v3 offset:28672
    ds_read_b64_tr_b16 a[174:175], v3 offset:29696
    ds_read_b64_tr_b16 a[176:177], v3 offset:32768
    ds_read_b64_tr_b16 a[178:179], v3 offset:33792
    ds_read_b64_tr_b16 a[180:181], v3 offset:36864
    ds_read_b64_tr_b16 a[182:183], v3 offset:37888
    ds_read_b64_tr_b16 a[184:185], v3 offset:40960
    ds_read_b64_tr_b16 a[186:187], v3 offset:41984
    ds_read_b64_tr_b16 a[188:189], v3 offset:45056
    ds_read_b64_tr_b16 a[190:191], v3 offset:46080
    s_waitcnt lgkmcnt(0)
    s_barrier
    s_cmp_eq_u32 s101, 1
    s_cbranch_scc1 Lxr_20
    s_mov_b32 s3, 0
Lslp_21:
    buffer_load_dword v152, v13, s[40:43], 0 offen sc1
    s_waitcnt vmcnt(0)
    v_cmp_gt_u32 vcc, 1, v152
    s_cbranch_vccz Lsdn_22
    s_sleep 1
    s_add_u32 s3, s3, 1
    s_cmp_lt_u32 s3, 200000
    s_cbranch_scc1 Lslp_21
Lsdn_22:
    s_mul_i32 s12, s33, 57344
    s_mul_i32 s13, s32, 7168
    s_add_u32 s12, s12, s13
    s_add_u32 s44, s30, 7340032
    s_addc_u32 s45, s31, 0
    s_mov_b32 s46, 1835008
    s_mov_b32 s47, 0x00020000
    s_add_u32 m0, s13, 7296
    s_add_u32 s14, s12, 0
    buffer_load_dwordx4 v5, s[44:47], s14 offen sc1 lds
    s_add_u32 m0, s13, 8320
    s_add_u32 s14, s12, 1024
    buffer_load_dwordx4 v5, s[44:47], s14 offen sc1 lds
    s_add_u32 m0, s13, 9344
    s_add_u32 s14, s12, 2048
    buffer_load_dwordx4 v5, s[44:47], s14 offen sc1 lds
    s_add_u32 m0, s13, 10368
    s_add_u32 s14, s12, 3072
    buffer_load_dwordx4 v5, s[44:47], s14 offen sc1 lds
    s_add_u32 m0, s13, 11392
    s_add_u32 s14, s12, 4096
    buffer_load_dwordx4 v5, s[44:47], s14 offen sc1 lds
    s_add_u32 m0, s13, 12416
    s_add_u32 s14, s12, 5120
    buffer_load_dwordx4 v5, s[44:47], s14 offen sc1 lds
    s_add_u32 m0, s13, 13440
    s_add_u32 s14, s12, 6144
    buffer_load_dwordx4 v5, s[44:47], s14 offen sc1 lds
    s_add_u32 m0, s13, 35968
    s_add_u32 s14, s12, 28672
    buffer_load_dwordx4 v5, s[44:47], s14 offen sc1 lds
    s_add_u32 m0, s13, 36992
    s_add_u32 s14, s12, 29696
    buffer_load_dwordx4 v5, s[44:47], s14 offen sc1 lds
    s_add_u32 m0, s13, 38016
    s_add_u32 s14, s12, 30720
    buffer_load_dwordx4 v5, s[44:47], s14 offen sc1 lds
    s_add_u32 m0, s13, 39040
    s_add_u32 s14, s12, 31744
    buffer_load_dwordx4 v5, s[44:47], s14 offen sc1 lds
    s_add_u32 m0, s13, 40064
    s_add_u32 s14, s12, 32768
    buffer_load_dwordx4 v5, s[44:47], s14 offen sc1 lds
    s_add_u32 m0, s13, 41088
    s_add_u32 s14, s12, 33792
    buffer_load_dwordx4 v5, s[44:47], s14 offen sc1 lds
    s_add_u32 m0, s13, 42112
    s_add_u32 s14, s12, 34816
    buffer_load_dwordx4 v5, s[44:47], s14 offen sc1 lds
Lxr_20:
    s_add_u32 m0, s8, 131072
    s_add_u32 s39, s9, 1376256
    buffer_load_dwordx4 v6, s[52:55], s39 offen lds
    s_add_u32 m0, s8, 135168
    s_add_u32 s39, s9, 1376256
    buffer_load_dwordx4 v6, s[56:59], s39 offen lds
    s_add_u32 m0, s8, 139264
    s_add_u32 s39, s9, 1433600
    buffer_load_dwordx4 v6, s[52:55], s39 offen lds
    s_add_u32 m0, s8, 143360
    s_add_u32 s39, s9, 1433600
    buffer_load_dwordx4 v6, s[56:59], s39 offen lds
    s_add_u32 m0, s8, 147456
    s_add_u32 s39, s9, 1490944
    buffer_load_dwordx4 v6, s[52:55], s39 offen lds
    s_add_u32 m0, s8, 151552
    s_add_u32 s39, s9, 1490944
    buffer_load_dwordx4 v6, s[56:59], s39 offen lds
    s_add_u32 m0, s8, 155648
    s_add_u32 s39, s9, 1548288
    buffer_load_dwordx4 v6, s[52:55], s39 offen lds
    s_add_u32 m0, s8, 159744
    s_add_u32 s39, s9, 1548288
    buffer_load_dwordx4 v6, s[56:59], s39 offen lds
    s_add_u32 s48, s30, 20971520
    s_addc_u32 s49, s31, 0
    s_mov_b32 s50, 1605632
    s_mov_b32 s51, 0x00020000
    s_add_u32 s52, s30, 9437184
    s_addc_u32 s53, s31, 0
    s_mov_b32 s54, 7340032
    s_mov_b32 s55, 0x00020000
    s_lshl_b32 s96, s35, 2
    s_add_u32 s96, s96, s32
    s_mul_i32 s96, s96, 57344
    s_lshl_b32 s98, s38, 2
    s_add_u32 s98, s98, s32
    s_lshl_b32 s98, s98, 11
    s_mul_i32 s99, s33, 229376
    s_add_u32 s98, s98, s99
    v_add_u32 v9, s98, v5
    s_mov_b32 s39, 0xbfb8aa3b
    v_add_u32 v8, 64640, v5
    v_add_u32 v10, 7296, v5
    s_lshl_b32 s3, s33, 8
    s_add_u32 s3, s3, 16416
    v_and_b32 v11, 31, v2
    v_add_u32 v11, s3, v11
    s_lshl_b32 s3, s33, 8
    s_add_u32 s3, s3, 16512
    v_and_b32 v12, 63, v2
    v_add_u32 v12, s3, v12
    s_waitcnt vmcnt(15)
    s_barrier
    ds_read_b128 v[80:83], v10 offset:0
    ds_read_b128 v[84:87], v10 offset:1024
    ds_read_b128 v[88:91], v10 offset:2048
    ds_read_b128 v[92:95], v10 offset:3072
    s_waitcnt lgkmcnt(3)
    v_mfma_f32_32x32x16_bf16 v[16:31], a[0:3], v[80:83], 0
    ds_read_b128 v[96:99], v10 offset:4096
    v_mfma_f32_32x32x16_bf16 v[32:47], a[4:7], v[80:83], 0
    s_waitcnt lgkmcnt(3)
    v_mfma_f32_32x32x16_bf16 v[16:31], a[8:11], v[84:87], v[16:31]
    ds_read_b128 v[100:103], v10 offset:5120
    v_mfma_f32_32x32x16_bf16 v[32:47], a[12:15], v[84:87], v[32:47]
    s_waitcnt lgkmcnt(3)
    v_mfma_f32_32x32x16_bf16 v[16:31], a[16:19], v[88:91], v[16:31]
    ds_read_b128 v[104:107], v10 offset:6144
    v_mfma_f32_32x32x16_bf16 v[32:47], a[20:23], v[88:91], v[32:47]
    s_waitcnt lgkmcnt(3)
    v_mfma_f32_32x32x16_bf16 v[16:31], a[24:27], v[92:95], v[16:31]
    ds_read_b128 v[108:111], v10 offset:7168
    v_mfma_f32_32x32x16_bf16 v[32:47], a[28:31], v[92:95], v[32:47]
    s_waitcnt lgkmcnt(3)
    v_mfma_f32_32x32x16_bf16 v[16:31], a[32:35], v[96:99], v[16:31]
    ds_read_b128 v[80:83], v10 offset:8192
    v_mfma_f32_32x32x16_bf16 v[32:47], a[36:39], v[96:99], v[32:47]
    s_waitcnt lgkmcnt(3)
    v_mfma_f32_32x32x16_bf16 v[16:31], a[40:43], v[100:103], v[16:31]
    ds_read_b128 v[84:87], v10 offset:9216
    v_mfma_f32_32x32x16_bf16 v[32:47], a[44:47], v[100:103], v[32:47]
    s_waitcnt lgkmcnt(3)
    v_mfma_f32_32x32x16_bf16 v[16:31], a[48:51], v[104:107], v[16:31]
    buffer_load_dword v13, v11, s[40:43], 0 offen sc1
    ds_read_b128 v[88:91], v10 offset:10240
    v_mfma_f32_32x32x16_bf16 v[32:47], a[52:55], v[104:107], v[32:47]
    s_waitcnt lgkmcnt(3)
    v_mfma_f32_32x32x16_bf16 v[16:31], a[56:59], v[108:111], v[16:31]
    ds_read_b128 v[92:95], v10 offset:11264
    v_mfma_f32_32x32x16_bf16 v[32:47], a[60:63], v[108:111], v[32:47]
    s_waitcnt lgkmcnt(3)
    v_mfma_f32_32x32x16_bf16 v[16:31], a[64:67], v[80:83], v[16:31]
    ds_read_b128 v[96:99], v10 offset:12288
    v_mfma_f32_32x32x16_bf16 v[32:47], a[68:71], v[80:83], v[32:47]
    s_waitcnt lgkmcnt(3)
    v_mfma_f32_32x32x16_bf16 v[16:31], a[72:75], v[84:87], v[16:31]
    ds_read_b128 v[100:103], v10 offset:13312
    v_mfma_f32_32x32x16_bf16 v[32:47], a[76:79], v[84:87], v[32:47]
    s_waitcnt lgkmcnt(3)
    v_mfma_f32_32x32x16_bf16 v[16:31], a[80:83], v[88:91], v[16:31]
    ds_read_b128 v[104:107], v10 offset:14336
    v_mfma_f32_32x32x16_bf16 v[32:47], a[84:87], v[88:91], v[32:47]
    s_waitcnt lgkmcnt(3)
    v_mfma_f32_32x32x16_bf16 v[16:31], a[88:91], v[92:95], v[16:31]
    ds_read_b128 v[108:111], v10 offset:15360
    v_mfma_f32_32x32x16_bf16 v[32:47], a[92:95], v[92:95], v[32:47]
    s_waitcnt lgkmcnt(3)
    v_mfma_f32_32x32x16_bf16 v[16:31], a[96:99], v[96:99], v[16:31]
    ds_read_b128 v[80:83], v10 offset:16384
    v_mfma_f32_32x32x16_bf16 v[32:47], a[100:103], v[96:99], v[32:47]
    s_waitcnt lgkmcnt(3)
    v_mfma_f32_32x32x16_bf16 v[16:31], a[104:107], v[100:103], v[16:31]
    ds_read_b128 v[84:87], v10 offset:17408
    v_mfma_f32_32x32x16_bf16 v[32:47], a[108:111], v[100:103], v[32:47]
    s_waitcnt lgkmcnt(3)
    v_mfma_f32_32x32x16_bf16 v[16:31], a[112:115], v[104:107], v[16:31]
    s_waitcnt vmcnt(1)
    s_barrier
    ds_read_b64_tr_b16 a[192:193], v3 offset:16384
    ds_read_b64_tr_b16 a[194:195], v3 offset:17408
    ds_read_b64_tr_b16 a[196:197], v3 offset:20480
    ds_read_b64_tr_b16 a[198:199], v3 offset:21504
    ds_read_b64_tr_b16 a[200:201], v3 offset:24576
    ds_read_b64_tr_b16 a[202:203], v3 offset:25600
    ds_read_b64_tr_b16 a[204:205], v3 offset:28672
    ds_read_b64_tr_b16 a[206:207], v3 offset:29696
    ds_read_b64_tr_b16 a[208:209], v3 offset:32768
    ds_read_b64_tr_b16 a[210:211], v3 offset:33792
    ds_read_b64_tr_b16 a[212:213], v3 offset:36864
    ds_read_b64_tr_b16 a[214:215], v3 offset:37888
    ds_read_b64_tr_b16 a[216:217], v3 offset:40960
    ds_read_b64_tr_b16 a[218:219], v3 offset:41984
    ds_read_b64_tr_b16 a[220:221], v3 offset:45056
    ds_read_b64_tr_b16 a[222:223], v3 offset:46080
    ds_read_b128 v[88:91], v10 offset:18432
    v_mfma_f32_32x32x16_bf16 v[32:47], a[116:119], v[104:107], v[32:47]
    s_waitcnt lgkmcnt(3)
    v_mfma_f32_32x32x16_bf16 v[16:31], a[120:123], v[108:111], v[16:31]
    ds_read_b128 v[92:95], v10 offset:19456
    v_mfma_f32_32x32x16_bf16 v[32:47], a[124:127], v[108:111], v[32:47]
    s_waitcnt lgkmcnt(3)
    v_mfma_f32_32x32x16_bf16 v[16:31], a[128:131], v[80:83], v[16:31]
    ds_read_b128 v[96:99], v10 offset:20480
    v_mfma_f32_32x32x16_bf16 v[32:47], a[132:135], v[80:83], v[32:47]
    s_waitcnt lgkmcnt(3)
    v_mfma_f32_32x32x16_bf16 v[16:31], a[136:139], v[84:87], v[16:31]
    ds_read_b128 v[100:103], v10 offset:21504
    v_mfma_f32_32x32x16_bf16 v[32:47], a[140:143], v[84:87], v[32:47]
    s_waitcnt lgkmcnt(3)
    v_mfma_f32_32x32x16_bf16 v[16:31], a[144:147], v[88:91], v[16:31]
    ds_read_b128 v[104:107], v10 offset:22528
    v_mfma_f32_32x32x16_bf16 v[32:47], a[148:151], v[88:91], v[32:47]
    s_waitcnt lgkmcnt(3)
    v_mfma_f32_32x32x16_bf16 v[16:31], a[152:155], v[92:95], v[16:31]
    ds_read_b128 v[108:111], v10 offset:23552
    v_mfma_f32_32x32x16_bf16 v[32:47], a[156:159], v[92:95], v[32:47]
    s_waitcnt lgkmcnt(3)
    v_mfma_f32_32x32x16_bf16 v[16:31], a[160:163], v[96:99], v[16:31]
    s_waitcnt vmcnt(0)
    v_cmp_gt_u32 vcc, 1, v13
    s_cbranch_vccz Lsdn_24
    s_mov_b32 s3, 0
Lslp_23:
    buffer_load_dword v13, v11, s[40:43], 0 offen sc1
    s_waitcnt vmcnt(0)
    v_cmp_gt_u32 vcc, 1, v13
    s_cbranch_vccz Lsdn_24
    s_sleep 1
    s_add_u32 s3, s3, 1
    s_cmp_lt_u32 s3, 200000
    s_cbranch_scc1 Lslp_23
Lsdn_24:
    s_mul_i32 s12, s33, 57344
    s_mul_i32 s13, s32, 7168
    s_add_u32 s12, s12, s13
    s_add_u32 s44, s30, 7340032
    s_addc_u32 s45, s31, 0
    s_mov_b32 s46, 1835008
    s_mov_b32 s47, 0x00020000
    s_add_u32 m0, s13, 64640
    s_add_u32 s14, s12, 917504
    buffer_load_dwordx4 v5, s[44:47], s14 offen sc1 lds
    ds_read_b128 v[80:83], v10 offset:24576
    v_mfma_f32_32x32x16_bf16 v[32:47], a[164:167], v[96:99], v[32:47]
    s_waitcnt lgkmcnt(3)
    v_mfma_f32_32x32x16_bf16 v[16:31], a[168:171], v[100:103], v[16:31]
    s_add_u32 m0, s13, 65664
    s_add_u32 s14, s12, 918528
    buffer_load_dwordx4 v5, s[44:47], s14 offen sc1 lds
    ds_read_b128 v[84:87], v10 offset:25600
    v_mfma_f32_32x32x16_bf16 v[32:47], a[172:175], v[100:103], v[32:47]
    s_waitcnt lgkmcnt(3)
    v_mfma_f32_32x32x16_bf16 v[16:31], a[176:179], v[104:107], v[16:31]
    s_add_u32 m0, s13, 66688
    s_add_u32 s14, s12, 919552
    buffer_load_dwordx4 v5, s[44:47], s14 offen sc1 lds
    ds_read_b128 v[88:91], v10 offset:26624
    v_mfma_f32_32x32x16_bf16 v[32:47], a[180:183], v[104:107], v[32:47]
    s_waitcnt lgkmcnt(3)
    v_mfma_f32_32x32x16_bf16 v[16:31], a[184:187], v[108:111], v[16:31]
    s_add_u32 m0, s13, 67712
    s_add_u32 s14, s12, 920576
    buffer_load_dwordx4 v5, s[44:47], s14 offen sc1 lds
    ds_read_b128 v[92:95], v10 offset:27648
    v_mfma_f32_32x32x16_bf16 v[32:47], a[188:191], v[108:111], v[32:47]
    s_waitcnt lgkmcnt(3)
    v_mfma_f32_32x32x16_bf16 v[16:31], a[192:195], v[80:83], v[16:31]
    s_add_u32 m0, s13, 68736
    s_add_u32 s14, s12, 921600
    buffer_load_dwordx4 v5, s[44:47], s14 offen sc1 lds
    s_waitcnt vmcnt(14)
    s_barrier
    ds_read_b128 v[96:99], v10 offset:28672
    v_mfma_f32_32x32x16_bf16 v[32:47], a[196:199], v[80:83], v[32:47]
    s_waitcnt lgkmcnt(3)
    v_mfma_f32_32x32x16_bf16 v[16:31], a[200:203], v[84:87], v[16:31]
    s_add_u32 m0, s13, 69760
    s_add_u32 s14, s12, 922624
    buffer_load_dwordx4 v5, s[44:47], s14 offen sc1 lds
    ds_read_b128 v[100:103], v10 offset:29696
    v_mfma_f32_32x32x16_bf16 v[32:47], a[204:207], v[84:87], v[32:47]
    s_waitcnt lgkmcnt(3)
    v_mfma_f32_32x32x16_bf16 v[16:31], a[208:211], v[88:91], v[16:31]
    s_add_u32 m0, s13, 70784
    s_add_u32 s14, s12, 923648
    buffer_load_dwordx4 v5, s[44:47], s14 offen sc1 lds
    ds_read_b128 v[104:107], v10 offset:30720
    v_mfma_f32_32x32x16_bf16 v[32:47], a[212:215], v[88:91], v[32:47]
    s_waitcnt lgkmcnt(3)
    v_mfma_f32_32x32x16_bf16 v[16:31], a[216:219], v[92:95], v[16:31]
    s_add_u32 m0, s13, 93312
    s_add_u32 s14, s12, 946176
    buffer_load_dwordx4 v5, s[44:47], s14 offen sc1 lds
    ds_read_b128 v[108:111], v10 offset:31744
    v_mfma_f32_32x32x16_bf16 v[32:47], a[220:223], v[92:95], v[32:47]
    s_waitcnt lgkmcnt(3)
    v_mfma_f32_32x32x16_bf16 v[48:63], a[0:3], v[96:99], 0
    s_add_u32 m0, s13, 94336
    s_add_u32 s14, s12, 947200
    buffer_load_dwordx4 v5, s[44:47], s14 offen sc1 lds
    ds_read_b128 v[80:83], v10 offset:32768
    v_mfma_f32_32x32x16_bf16 v[64:79], a[4:7], v[96:99], 0
    s_waitcnt lgkmcnt(3)
    v_mfma_f32_32x32x16_bf16 v[48:63], a[8:11], v[100:103], v[48:63]
    s_add_u32 m0, s13, 95360
    s_add_u32 s14, s12, 948224
    buffer_load_dwordx4 v5, s[44:47], s14 offen sc1 lds
    ds_read_b128 v[84:87], v10 offset:33792
    v_mfma_f32_32x32x16_bf16 v[64:79], a[12:15], v[100:103], v[64:79]
    s_waitcnt lgkmcnt(3)
    v_mfma_f32_32x32x16_bf16 v[48:63], a[16:19], v[104:107], v[48:63]
    s_add_u32 m0, s13, 96384
    s_add_u32 s14, s12, 949248
    buffer_load_dwordx4 v5, s[44:47], s14 offen sc1 lds
    ds_read_b128 v[88:91], v10 offset:34816
    v_mfma_f32_32x32x16_bf16 v[64:79], a[20:23], v[104:107], v[64:79]
    s_add_u32 s97, s96, 0
    buffer_load_dwordx4 v[144:147], v5, s[48:51], s97 offen offset:0 sc1
    buffer_load_dwordx4 v[148:151], v5, s[48:51], s97 offen offset:1024 sc1
    s_waitcnt lgkmcnt(3)
    v_mfma_f32_32x32x16_bf16 v[48:63], a[24:27], v[108:111], v[48:63]
    s_add_u32 m0, s13, 97408
    s_add_u32 s14, s12, 950272
    buffer_load_dwordx4 v5, s[44:47], s14 offen sc1 lds
    ds_read_b128 v[92:95], v10 offset:35840
    v_cvt_pk_bf16_f32 v128, v16, v17
    v_cvt_pk_bf16_f32 v129, v18, v19
    v_cvt_pk_bf16_f32 v130, v20, v21
    v_cvt_pk_bf16_f32 v131, v22, v23
    v_mfma_f32_32x32x16_bf16 v[64:79], a[28:31], v[108:111], v[64:79]
    v_cvt_pk_bf16_f32 v132, v24, v25
    v_cvt_pk_bf16_f32 v133, v26, v27
    v_cvt_pk_bf16_f32 v134, v28, v29
    v_cvt_pk_bf16_f32 v135, v30, v31
    v_lshlrev_b32 v16, 16, v128
    s_waitcnt lgkmcnt(3)
    v_mfma_f32_32x32x16_bf16 v[48:63], a[32:35], v[80:83], v[48:63]
    s_add_u32 m0, s13, 98432
    s_add_u32 s14, s12, 951296
    buffer_load_dwordx4 v5, s[44:47], s14 offen sc1 lds
    ds_read_b128 v[96:99], v10 offset:36864
    v_and_b32 v17, 0xffff0000, v128
    v_lshlrev_b32 v18, 16, v129
    v_and_b32 v19, 0xffff0000, v129
    v_lshlrev_b32 v20, 16, v130
    v_mfma_f32_32x32x16_bf16 v[64:79], a[36:39], v[80:83], v[64:79]
    v_and_b32 v21, 0xffff0000, v130
    v_lshlrev_b32 v22, 16, v131
    v_and_b32 v23, 0xffff0000, v131
    v_lshlrev_b32 v24, 16, v132
    v_and_b32 v25, 0xffff0000, v132
    s_waitcnt lgkmcnt(3)
    v_mfma_f32_32x32x16_bf16 v[48:63], a[40:43], v[84:87], v[48:63]
    s_add_u32 m0, s13, 99456
    s_add_u32 s14, s12, 952320
    buffer_load_dwordx4 v5, s[44:47], s14 offen sc1 lds
    ds_read_b128 v[100:103], v10 offset:37888
    v_lshlrev_b32 v26, 16, v133
    v_and_b32 v27, 0xffff0000, v133
    v_lshlrev_b32 v28, 16, v134
    v_and_b32 v29, 0xffff0000, v134
    v_mfma_f32_32x32x16_bf16 v[64:79], a[44:47], v[84:87], v[64:79]
    v_lshlrev_b32 v30, 16, v135
    v_and_b32 v31, 0xffff0000, v135
    v_mul_f32 v112, s39, v16
    v_mul_f32 v113, s39, v17
    v_mul_f32 v114, s39, v18
    s_add_u32 s97, s96, 2048
    buffer_load_dwordx4 v[152:155], v5, s[48:51], s97 offen offset:0 sc1
    buffer_load_dwordx4 v[156:159], v5, s[48:51], s97 offen offset:1024 sc1
    s_waitcnt lgkmcnt(3)
    v_mfma_f32_32x32x16_bf16 v[48:63], a[48:51], v[88:91], v[48:63]
    ds_read_b128 v[104:107], v10 offset:38912
    v_mul_f32 v115, s39, v19
    v_mul_f32 v116, s39, v20
    v_mul_f32 v117, s39, v21
    v_mul_f32 v118, s39, v22
    v_mfma_f32_32x32x16_bf16 v[64:79], a[52:55], v[88:91], v[64:79]
    v_mul_f32 v119, s39, v23
    v_mul_f32 v120, s39, v24
    v_mul_f32 v121, s39, v25
    v_mul_f32 v122, s39, v26
    v_mul_f32 v123, s39, v27
    s_waitcnt lgkmcnt(3)
    v_mfma_f32_32x32x16_bf16 v[48:63], a[56:59], v[92:95], v[48:63]
    ds_read_b128 v[108:111], v10 offset:39936
    v_mul_f32 v124, s39, v28
    v_mul_f32 v125, s39, v29
    v_mul_f32 v126, s39, v30
    v_mul_f32 v127, s39, v31
    v_mfma_f32_32x32x16_bf16 v[64:79], a[60:63], v[92:95], v[64:79]
    v_exp_f32 v112, v112
    v_exp_f32 v113, v113
    s_waitcnt lgkmcnt(3)
    v_mfma_f32_32x32x16_bf16 v[48:63], a[64:67], v[96:99], v[48:63]
    ds_read_b128 v[80:83], v10 offset:40960
    v_exp_f32 v114, v114
    v_exp_f32 v115, v115
    v_mfma_f32_32x32x16_bf16 v[64:79], a[68:71], v[96:99], v[64:79]
    v_exp_f32 v116, v116
    v_exp_f32 v117, v117
    s_add_u32 s97, s96, 4096
    buffer_load_dwordx4 v[160:163], v5, s[48:51], s97 offen offset:0 sc1
    buffer_load_dwordx4 v[164:167], v5, s[48:51], s97 offen offset:1024 sc1
    s_waitcnt lgkmcnt(3)
    v_mfma_f32_32x32x16_bf16 v[48:63], a[72:75], v[100:103], v[48:63]
    ds_read_b128 v[84:87], v10 offset:41984
    v_exp_f32 v118, v118
    v_exp_f32 v119, v119
    v_mfma_f32_32x32x16_bf16 v[64:79], a[76:79], v[100:103], v[64:79]
    v_exp_f32 v120, v120
    v_exp_f32 v121, v121
    s_waitcnt lgkmcnt(3)
    v_mfma_f32_32x32x16_bf16 v[48:63], a[80:83], v[104:107], v[48:63]
    ds_read_b128 v[88:91], v10 offset:43008
    v_exp_f32 v122, v122
    v_exp_f32 v123, v123
    v_mfma_f32_32x32x16_bf16 v[64:79], a[84:87], v[104:107], v[64:79]
    v_exp_f32 v124, v124
    v_exp_f32 v125, v125
    s_waitcnt lgkmcnt(3)
    v_mfma_f32_32x32x16_bf16 v[48:63], a[88:91], v[108:111], v[48:63]
    ds_read_b128 v[92:95], v10 offset:44032
    v_exp_f32 v126, v126
    v_exp_f32 v127, v127
    v_mfma_f32_32x32x16_bf16 v[64:79], a[92:95], v[108:111], v[64:79]
    v_cvt_pk_bf16_f32 v128, v32, v33
    v_cvt_pk_bf16_f32 v129, v34, v35
    v_cvt_pk_bf16_f32 v130, v36, v37
    v_cvt_pk_bf16_f32 v131, v38, v39
    v_cvt_pk_bf16_f32 v132, v40, v41
    s_add_u32 s97, s96, 6144
    buffer_load_dwordx4 v[168:171], v5, s[48:51], s97 offen offset:0 sc1
    buffer_load_dwordx4 v[172:175], v5, s[48:51], s97 offen offset:1024 sc1
    s_waitcnt lgkmcnt(3)
    v_mfma_f32_32x32x16_bf16 v[48:63], a[96:99], v[80:83], v[48:63]
    ds_read_b128 v[96:99], v10 offset:45056
    v_cvt_pk_bf16_f32 v133, v42, v43
    v_cvt_pk_bf16_f32 v134, v44, v45
    v_cvt_pk_bf16_f32 v135, v46, v47
    v_add_f32 v112, 1.0, v112
    v_mfma_f32_32x32x16_bf16 v[64:79], a[100:103], v[80:83], v[64:79]
    v_add_f32 v113, 1.0, v113
    v_add_f32 v114, 1.0, v114
    v_add_f32 v115, 1.0, v115
    v_add_f32 v116, 1.0, v116
    v_add_f32 v117, 1.0, v117
    s_waitcnt lgkmcnt(3)
    v_mfma_f32_32x32x16_bf16 v[48:63], a[104:107], v[84:87], v[48:63]
    ds_read_b128 v[100:103], v10 offset:46080
    v_add_f32 v118, 1.0, v118
    v_add_f32 v119, 1.0, v119
    v_add_f32 v120, 1.0, v120
    v_add_f32 v121, 1.0, v121
    v_mfma_f32_32x32x16_bf16 v[64:79], a[108:111], v[84:87], v[64:79]
    v_add_f32 v122, 1.0, v122
    v_add_f32 v123, 1.0, v123
    v_add_f32 v124, 1.0, v124
    v_add_f32 v125, 1.0, v125
    v_add_f32 v126, 1.0, v126
    s_waitcnt lgkmcnt(3)
    v_mfma_f32_32x32x16_bf16 v[48:63], a[112:115], v[88:91], v[48:63]
    ds_read_b128 v[104:107], v10 offset:47104
    v_add_f32 v127, 1.0, v127
    v_rcp_f32 v112, v112
    v_mfma_f32_32x32x16_bf16 v[64:79], a[116:119], v[88:91], v[64:79]
    v_rcp_f32 v113, v113
    v_rcp_f32 v114, v114
    s_add_u32 s97, s96, 8192
    buffer_load_dwordx4 v[176:179], v5, s[48:51], s97 offen offset:0 sc1
    buffer_load_dwordx4 v[180:183], v5, s[48:51], s97 offen offset:1024 sc1
    s_waitcnt lgkmcnt(3)
    v_mfma_f32_32x32x16_bf16 v[48:63], a[120:123], v[92:95], v[48:63]
    ds_read_b128 v[108:111], v10 offset:48128
    v_rcp_f32 v115, v115
    v_rcp_f32 v116, v116
    v_mfma_f32_32x32x16_bf16 v[64:79], a[124:127], v[92:95], v[64:79]
    v_rcp_f32 v117, v117
    v_rcp_f32 v118, v118
    s_waitcnt lgkmcnt(3)
    v_mfma_f32_32x32x16_bf16 v[48:63], a[128:131], v[96:99], v[48:63]
    ds_read_b128 v[80:83], v10 offset:49152
    v_rcp_f32 v119, v119
    v_rcp_f32 v120, v120
    v_mfma_f32_32x32x16_bf16 v[64:79], a[132:135], v[96:99], v[64:79]
    v_rcp_f32 v121, v121
    v_rcp_f32 v122, v122
    s_waitcnt lgkmcnt(3)
    v_mfma_f32_32x32x16_bf16 v[48:63], a[136:139], v[100:103], v[48:63]
    ds_read_b128 v[84:87], v10 offset:50176
    v_rcp_f32 v123, v123
    v_rcp_f32 v124, v124
    v_mfma_f32_32x32x16_bf16 v[64:79], a[140:143], v[100:103], v[64:79]
    v_rcp_f32 v125, v125
    v_rcp_f32 v126, v126
    s_add_u32 s97, s96, 10240
    buffer_load_dwordx4 v[184:187], v5, s[48:51], s97 offen offset:0 sc1
    buffer_load_dwordx4 v[188:191], v5, s[48:51], s97 offen offset:1024 sc1
    s_waitcnt lgkmcnt(3)
    v_mfma_f32_32x32x16_bf16 v[48:63], a[144:147], v[104:107], v[48:63]
    ds_read_b128 v[88:91], v10 offset:51200
    v_rcp_f32 v127, v127
    v_lshlrev_b32 v32, 16, v128
    v_and_b32 v33, 0xffff0000, v128
    v_mfma_f32_32x32x16_bf16 v[64:79], a[148:151], v[104:107], v[64:79]
    v_lshlrev_b32 v34, 16, v129
    v_and_b32 v35, 0xffff0000, v129
    v_lshlrev_b32 v36, 16, v130
    v_and_b32 v37, 0xffff0000, v130
    v_lshlrev_b32 v38, 16, v131
    s_waitcnt lgkmcnt(3)
    v_mfma_f32_32x32x16_bf16 v[48:63], a[152:155], v[108:111], v[48:63]
    ds_read_b128 v[92:95], v10 offset:52224
    v_and_b32 v39, 0xffff0000, v131
    v_lshlrev_b32 v40, 16, v132
    v_and_b32 v41, 0xffff0000, v132
    v_lshlrev_b32 v42, 16, v133
    v_mfma_f32_32x32x16_bf16 v[64:79], a[156:159], v[108:111], v[64:79]
    v_and_b32 v43, 0xffff0000, v133
    v_lshlrev_b32 v44, 16, v134
    v_and_b32 v45, 0xffff0000, v134
    v_lshlrev_b32 v46, 16, v135
    v_and_b32 v47, 0xffff0000, v135
    s_waitcnt lgkmcnt(3)
    v_mfma_f32_32x32x16_bf16 v[48:63], a[160:163], v[80:83], v[48:63]
    ds_read_b128 v[96:99], v10 offset:53248
    v_mul_f32 v16, v16, v112
    v_mul_f32 v17, v17, v113
    v_mul_f32 v18, v18, v114
    v_mul_f32 v19, v19, v115
    v_mfma_f32_32x32x16_bf16 v[64:79], a[164:167], v[80:83], v[64:79]
    v_mul_f32 v20, v20, v116
    v_mul_f32 v21, v21, v117
    v_mul_f32 v22, v22, v118
    v_mul_f32 v23, v23, v119
    v_mul_f32 v24, v24, v120
    s_add_u32 s97, s96, 12288
    buffer_load_dwordx4 v[192:195], v5, s[48:51], s97 offen offset:0 sc1
    buffer_load_dwordx4 v[196:199], v5, s[48:51], s97 offen offset:1024 sc1
    s_waitcnt lgkmcnt(3)
    v_mfma_f32_32x32x16_bf16 v[48:63], a[168:171], v[84:87], v[48:63]
    ds_read_b128 v[100:103], v10 offset:54272
    v_mul_f32 v25, v25, v121
    v_mul_f32 v26, v26, v122
    v_mul_f32 v27, v27, v123
    v_mul_f32 v28, v28, v124
    v_mfma_f32_32x32x16_bf16 v[64:79], a[172:175], v[84:87], v[64:79]
    v_mul_f32 v29, v29, v125
    v_mul_f32 v30, v30, v126
    v_mul_f32 v31, v31, v127
    v_cvt_pk_bf16_f32 v128, v16, v17
    v_cvt_pk_bf16_f32 v129, v18, v19
    s_waitcnt lgkmcnt(3)
    v_mfma_f32_32x32x16_bf16 v[48:63], a[176:179], v[88:91], v[48:63]
    ds_read_b128 v[104:107], v10 offset:55296
    v_cvt_pk_bf16_f32 v130, v20, v21
    v_cvt_pk_bf16_f32 v131, v22, v23
    v_cvt_pk_bf16_f32 v132, v24, v25
    v_cvt_pk_bf16_f32 v133, v26, v27
    v_mfma_f32_32x32x16_bf16 v[64:79], a[180:183], v[88:91], v[64:79]
    v_cvt_pk_bf16_f32 v134, v28, v29
    v_cvt_pk_bf16_f32 v135, v30, v31
    v_lshlrev_b32 v16, 16, v128
    v_and_b32 v17, 0xffff0000, v128
    v_lshlrev_b32 v18, 16, v129
    s_waitcnt lgkmcnt(3)
    v_mfma_f32_32x32x16_bf16 v[48:63], a[184:187], v[92:95], v[48:63]
    ds_read_b128 v[108:111], v10 offset:56320
    v_and_b32 v19, 0xffff0000, v129
    v_lshlrev_b32 v20, 16, v130
    v_and_b32 v21, 0xffff0000, v130
    v_lshlrev_b32 v22, 16, v131
    v_mfma_f32_32x32x16_bf16 v[64:79], a[188:191], v[92:95], v[64:79]
    v_and_b32 v23, 0xffff0000, v131
    v_lshlrev_b32 v24, 16, v132
    v_and_b32 v25, 0xffff0000, v132
    v_lshlrev_b32 v26, 16, v133
    v_and_b32 v27, 0xffff0000, v133
    s_add_u32 s97, s96, 14336
    buffer_load_dwordx4 v[200:203], v5, s[48:51], s97 offen offset:0 sc1
    buffer_load_dwordx4 v[204:207], v5, s[48:51], s97 offen offset:1024 sc1
    s_waitcnt lgkmcnt(3)
    v_mfma_f32_32x32x16_bf16 v[48:63], a[192:195], v[96:99], v[48:63]
    s_waitcnt vmcnt(23)
    s_barrier
    ds_read_b128 v[80:83], v8 offset:0
    v_lshlrev_b32 v28, 16, v134
    v_and_b32 v29, 0xffff0000, v134
    v_lshlrev_b32 v30, 16, v135
    v_and_b32 v31, 0xffff0000, v135
    v_mfma_f32_32x32x16_bf16 v[64:79], a[196:199], v[96:99], v[64:79]
    v_mul_f32 v16, v16, v32
    v_mul_f32 v17, v17, v33
    v_mul_f32 v18, v18, v34
    v_mul_f32 v19, v19, v35
    v_mul_f32 v20, v20, v36
    s_waitcnt lgkmcnt(3)
    v_mfma_f32_32x32x16_bf16 v[48:63], a[200:203], v[100:103], v[48:63]
    ds_read_b128 v[84:87], v8 offset:1024
    v_mul_f32 v21, v21, v37
    v_mul_f32 v22, v22, v38
    v_mul_f32 v23, v23, v39
    v_mul_f32 v24, v24, v40
    v_mfma_f32_32x32x16_bf16 v[64:79], a[204:207], v[100:103], v[64:79]
    v_mul_f32 v25, v25, v41
    v_mul_f32 v26, v26, v42
    v_mul_f32 v27, v27, v43
    v_mul_f32 v28, v28, v44
    v_mul_f32 v29, v29, v45
    s_waitcnt lgkmcnt(3)
    v_mfma_f32_32x32x16_bf16 v[48:63], a[208:211], v[104:107], v[48:63]
    ds_read_b128 v[88:91], v8 offset:2048
    v_mul_f32 v30, v30, v46
    v_mul_f32 v31, v31, v47
    v_cvt_pk_bf16_f32 v136, v16, v17
    v_cvt_pk_bf16_f32 v137, v18, v19
    v_mfma_f32_32x32x16_bf16 v[64:79], a[212:215], v[104:107], v[64:79]
    v_cvt_pk_bf16_f32 v138, v20, v21
    v_cvt_pk_bf16_f32 v139, v22, v23
    v_cvt_pk_bf16_f32 v140, v24, v25
    v_cvt_pk_bf16_f32 v141, v26, v27
    v_cvt_pk_bf16_f32 v142, v28, v29
    s_add_u32 s97, s96, 16384
    buffer_load_dwordx4 v[208:211], v5, s[48:51], s97 offen offset:0 sc1
    buffer_load_dwordx4 v[212:215], v5, s[48:51], s97 offen offset:1024 sc1
    s_waitcnt lgkmcnt(3)
    v_mfma_f32_32x32x16_bf16 v[48:63], a[216:219], v[108:111], v[48:63]
    ds_read_b128 v[92:95], v8 offset:3072
    v_cvt_pk_bf16_f32 v143, v30, v31
    s_mov_b32 s99, 0
    buffer_store_dwordx4 v[136:139], v9, s[52:55], s99 offen sc1
    buffer_store_dwordx4 v[140:143], v9, s[52:55], s99 offen offset:1024 sc1
    v_mfma_f32_32x32x16_bf16 v[64:79], a[220:223], v[108:111], v[64:79]
    s_waitcnt lgkmcnt(3)
    v_mfma_f32_32x32x16_bf16 v[16:31], a[0:3], v[80:83], 0
    ds_read_b128 v[96:99], v8 offset:4096
    v_mfma_f32_32x32x16_bf16 v[32:47], a[4:7], v[80:83], 0
    s_waitcnt lgkmcnt(3)
    v_mfma_f32_32x32x16_bf16 v[16:31], a[8:11], v[84:87], v[16:31]
    ds_read_b128 v[100:103], v8 offset:5120
    v_mfma_f32_32x32x16_bf16 v[32:47], a[12:15], v[84:87], v[32:47]
    s_waitcnt lgkmcnt(3)
    v_mfma_f32_32x32x16_bf16 v[16:31], a[16:19], v[88:91], v[16:31]
    ds_read_b128 v[104:107], v8 offset:6144
    v_mfma_f32_32x32x16_bf16 v[32:47], a[20:23], v[88:91], v[32:47]
    s_add_u32 s97, s96, 18432
    buffer_load_dwordx4 v[216:219], v5, s[48:51], s97 offen offset:0 sc1
    buffer_load_dwordx4 v[220:223], v5, s[48:51], s97 offen offset:1024 sc1
    s_waitcnt lgkmcnt(3)
    v_mfma_f32_32x32x16_bf16 v[16:31], a[24:27], v[92:95], v[16:31]
    ds_read_b128 v[108:111], v8 offset:7168
    v_cvt_pk_bf16_f32 v128, v48, v49
    v_cvt_pk_bf16_f32 v129, v50, v51
    v_cvt_pk_bf16_f32 v130, v52, v53
    v_cvt_pk_bf16_f32 v131, v54, v55
    v_mfma_f32_32x32x16_bf16 v[32:47], a[28:31], v[92:95], v[32:47]
    v_cvt_pk_bf16_f32 v132, v56, v57
    v_cvt_pk_bf16_f32 v133, v58, v59
    v_cvt_pk_bf16_f32 v134, v60, v61
    v_cvt_pk_bf16_f32 v135, v62, v63
    v_lshlrev_b32 v48, 16, v128
    s_waitcnt lgkmcnt(3)
    v_mfma_f32_32x32x16_bf16 v[16:31], a[32:35], v[96:99], v[16:31]
    ds_read_b128 v[80:83], v8 offset:8192
    v_and_b32 v49, 0xffff0000, v128
    v_lshlrev_b32 v50, 16, v129
    v_and_b32 v51, 0xffff0000, v129
    v_lshlrev_b32 v52, 16, v130
    v_mfma_f32_32x32x16_bf16 v[32:47], a[36:39], v[96:99], v[32:47]
    v_and_b32 v53, 0xffff0000, v130
    v_lshlrev_b32 v54, 16, v131
    v_and_b32 v55, 0xffff0000, v131
    v_lshlrev_b32 v56, 16, v132
    v_and_b32 v57, 0xffff0000, v132
    s_waitcnt lgkmcnt(3)
    v_mfma_f32_32x32x16_bf16 v[16:31], a[40:43], v[100:103], v[16:31]
    ds_read_b128 v[84:87], v8 offset:9216
    v_lshlrev_b32 v58, 16, v133
    v_and_b32 v59, 0xffff0000, v133
    v_lshlrev_b32 v60, 16, v134
    v_and_b32 v61, 0xffff0000, v134
    v_mfma_f32_32x32x16_bf16 v[32:47], a[44:47], v[100:103], v[32:47]
    v_lshlrev_b32 v62, 16, v135
    v_and_b32 v63, 0xffff0000, v135
    v_mul_f32 v112, s39, v48
    v_mul_f32 v113, s39, v49
    v_mul_f32 v114, s39, v50
    s_add_u32 s97, s96, 20480
    buffer_load_dwordx4 v[224:227], v5, s[48:51], s97 offen offset:0 sc1
    buffer_load_dwordx4 v[228:231], v5, s[48:51], s97 offen offset:1024 sc1
    s_waitcnt lgkmcnt(3)
    v_mfma_f32_32x32x16_bf16 v[16:31], a[48:51], v[104:107], v[16:31]
    ds_read_b128 v[88:91], v8 offset:10240
    v_mul_f32 v115, s39, v51
    v_mul_f32 v116, s39, v52
    v_mul_f32 v117, s39, v53
    v_mul_f32 v118, s39, v54
    v_mfma_f32_32x32x16_bf16 v[32:47], a[52:55], v[104:107], v[32:47]
    v_mul_f32 v119, s39, v55
    v_mul_f32 v120, s39, v56
    v_mul_f32 v121, s39, v57
    v_mul_f32 v122, s39, v58
    v_mul_f32 v123, s39, v59
    s_waitcnt lgkmcnt(3)
    v_mfma_f32_32x32x16_bf16 v[16:31], a[56:59], v[108:111], v[16:31]
    ds_read_b128 v[92:95], v8 offset:11264
    v_mul_f32 v124, s39, v60
    v_mul_f32 v125, s39, v61
    v_mul_f32 v126, s39, v62
    v_mul_f32 v127, s39, v63
    v_mfma_f32_32x32x16_bf16 v[32:47], a[60:63], v[108:111], v[32:47]
    v_exp_f32 v112, v112
    v_exp_f32 v113, v113
    s_waitcnt lgkmcnt(3)
    v_mfma_f32_32x32x16_bf16 v[16:31], a[64:67], v[80:83], v[16:31]
    ds_read_b128 v[96:99], v8 offset:12288
    v_exp_f32 v114, v114
    v_exp_f32 v115, v115
    v_mfma_f32_32x32x16_bf16 v[32:47], a[68:71], v[80:83], v[32:47]
    v_exp_f32 v116, v116
    v_exp_f32 v117, v117
    s_add_u32 s97, s96, 22528
    buffer_load_dwordx4 v[232:235], v5, s[48:51], s97 offen offset:0 sc1
    buffer_load_dwordx4 v[236:239], v5, s[48:51], s97 offen offset:1024 sc1
    s_waitcnt lgkmcnt(3)
    v_mfma_f32_32x32x16_bf16 v[16:31], a[72:75], v[84:87], v[16:31]
    ds_read_b128 v[100:103], v8 offset:13312
    v_exp_f32 v118, v118
    v_exp_f32 v119, v119
    v_mfma_f32_32x32x16_bf16 v[32:47], a[76:79], v[84:87], v[32:47]
    v_exp_f32 v120, v120
    v_exp_f32 v121, v121
    s_waitcnt lgkmcnt(3)
    v_mfma_f32_32x32x16_bf16 v[16:31], a[80:83], v[88:91], v[16:31]
    ds_read_b128 v[104:107], v8 offset:14336
    v_exp_f32 v122, v122
    v_exp_f32 v123, v123
    v_mfma_f32_32x32x16_bf16 v[32:47], a[84:87], v[88:91], v[32:47]
    v_exp_f32 v124, v124
    v_exp_f32 v125, v125
    s_waitcnt lgkmcnt(3)
    v_mfma_f32_32x32x16_bf16 v[16:31], a[88:91], v[92:95], v[16:31]
    ds_read_b128 v[108:111], v8 offset:15360
    v_exp_f32 v126, v126
    v_exp_f32 v127, v127
    v_mfma_f32_32x32x16_bf16 v[32:47], a[92:95], v[92:95], v[32:47]
    v_cvt_pk_bf16_f32 v128, v64, v65
    v_cvt_pk_bf16_f32 v129, v66, v67
    v_cvt_pk_bf16_f32 v130, v68, v69
    v_cvt_pk_bf16_f32 v131, v70, v71
    v_cvt_pk_bf16_f32 v132, v72, v73
    s_add_u32 s97, s96, 24576
    buffer_load_dwordx4 v[240:243], v5, s[48:51], s97 offen offset:0 sc1
    buffer_load_dwordx4 v[244:247], v5, s[48:51], s97 offen offset:1024 sc1
    s_waitcnt lgkmcnt(3)
    v_mfma_f32_32x32x16_bf16 v[16:31], a[96:99], v[96:99], v[16:31]
    ds_read_b128 v[80:83], v8 offset:16384
    v_cvt_pk_bf16_f32 v133, v74, v75
    v_cvt_pk_bf16_f32 v134, v76, v77
    v_cvt_pk_bf16_f32 v135, v78, v79
    v_add_f32 v112, 1.0, v112
    v_mfma_f32_32x32x16_bf16 v[32:47], a[100:103], v[96:99], v[32:47]
    v_add_f32 v113, 1.0, v113
    v_add_f32 v114, 1.0, v114
    v_add_f32 v115, 1.0, v115
    v_add_f32 v116, 1.0, v116
    v_add_f32 v117, 1.0, v117
    s_waitcnt lgkmcnt(3)
    v_mfma_f32_32x32x16_bf16 v[16:31], a[104:107], v[100:103], v[16:31]
    ds_read_b128 v[84:87], v8 offset:17408
    v_add_f32 v118, 1.0, v118
    v_add_f32 v119, 1.0, v119
    v_add_f32 v120, 1.0, v120
    v_add_f32 v121, 1.0, v121
    v_mfma_f32_32x32x16_bf16 v[32:47], a[108:111], v[100:103], v[32:47]
    v_add_f32 v122, 1.0, v122
    v_add_f32 v123, 1.0, v123
    v_add_f32 v124, 1.0, v124
    v_add_f32 v125, 1.0, v125
    v_add_f32 v126, 1.0, v126
    s_waitcnt lgkmcnt(3)
    v_mfma_f32_32x32x16_bf16 v[16:31], a[112:115], v[104:107], v[16:31]
    ds_read_b128 v[88:91], v8 offset:18432
    v_add_f32 v127, 1.0, v127
    v_rcp_f32 v112, v112
    v_mfma_f32_32x32x16_bf16 v[32:47], a[116:119], v[104:107], v[32:47]
    v_rcp_f32 v113, v113
    v_rcp_f32 v114, v114
    s_add_u32 s97, s96, 26624
    buffer_load_dwordx4 v[248:251], v5, s[48:51], s97 offen offset:0 sc1
    buffer_load_dwordx4 v[252:255], v5, s[48:51], s97 offen offset:1024 sc1
    s_waitcnt lgkmcnt(3)
    v_mfma_f32_32x32x16_bf16 v[16:31], a[120:123], v[108:111], v[16:31]
    ds_read_b128 v[92:95], v8 offset:19456
    v_rcp_f32 v115, v115
    v_rcp_f32 v116, v116
    v_mfma_f32_32x32x16_bf16 v[32:47], a[124:127], v[108:111], v[32:47]
    v_rcp_f32 v117, v117
    v_rcp_f32 v118, v118
    s_waitcnt lgkmcnt(3)
    v_mfma_f32_32x32x16_bf16 v[16:31], a[128:131], v[80:83], v[16:31]
    ds_read_b128 v[96:99], v8 offset:20480
    v_rcp_f32 v119, v119
    v_rcp_f32 v120, v120
    v_mfma_f32_32x32x16_bf16 v[32:47], a[132:135], v[80:83], v[32:47]
    v_rcp_f32 v121, v121
    v_rcp_f32 v122, v122
    s_waitcnt lgkmcnt(3)
    v_mfma_f32_32x32x16_bf16 v[16:31], a[136:139], v[84:87], v[16:31]
    ds_read_b128 v[100:103], v8 offset:21504
    v_rcp_f32 v123, v123
    v_rcp_f32 v124, v124
    v_mfma_f32_32x32x16_bf16 v[32:47], a[140:143], v[84:87], v[32:47]
    v_rcp_f32 v125, v125
    v_rcp_f32 v126, v126
    s_add_u32 s97, s96, 28672
    buffer_load_dwordx4 a[224:227], v5, s[48:51], s97 offen offset:0 sc1
    buffer_load_dwordx4 a[228:231], v5, s[48:51], s97 offen offset:1024 sc1
    s_waitcnt lgkmcnt(3)
    v_mfma_f32_32x32x16_bf16 v[16:31], a[144:147], v[88:91], v[16:31]
    ds_read_b128 v[104:107], v8 offset:22528
    v_rcp_f32 v127, v127
    v_lshlrev_b32 v64, 16, v128
    v_and_b32 v65, 0xffff0000, v128
    v_mfma_f32_32x32x16_bf16 v[32:47], a[148:151], v[88:91], v[32:47]
    v_lshlrev_b32 v66, 16, v129
    v_and_b32 v67, 0xffff0000, v129
    v_lshlrev_b32 v68, 16, v130
    v_and_b32 v69, 0xffff0000, v130
    v_lshlrev_b32 v70, 16, v131
    s_waitcnt lgkmcnt(3)
    v_mfma_f32_32x32x16_bf16 v[16:31], a[152:155], v[92:95], v[16:31]
    ds_read_b128 v[108:111], v8 offset:23552
    v_and_b32 v71, 0xffff0000, v131
    v_lshlrev_b32 v72, 16, v132
    v_and_b32 v73, 0xffff0000, v132
    v_lshlrev_b32 v74, 16, v133
    v_mfma_f32_32x32x16_bf16 v[32:47], a[156:159], v[92:95], v[32:47]
    v_and_b32 v75, 0xffff0000, v133
    v_lshlrev_b32 v76, 16, v134
    v_and_b32 v77, 0xffff0000, v134
    v_lshlrev_b32 v78, 16, v135
    v_and_b32 v79, 0xffff0000, v135
    s_waitcnt lgkmcnt(3)
    v_mfma_f32_32x32x16_bf16 v[16:31], a[160:163], v[96:99], v[16:31]
    ds_read_b128 v[80:83], v8 offset:24576
    v_mul_f32 v48, v48, v112
    v_mul_f32 v49, v49, v113
    v_mul_f32 v50, v50, v114
    v_mul_f32 v51, v51, v115
    v_mfma_f32_32x32x16_bf16 v[32:47], a[164:167], v[96:99], v[32:47]
    v_mul_f32 v52, v52, v116
    v_mul_f32 v53, v53, v117
    v_mul_f32 v54, v54, v118
    v_mul_f32 v55, v55, v119
    v_mul_f32 v56, v56, v120
    s_add_u32 s97, s96, 30720
    buffer_load_dwordx4 a[232:235], v5, s[48:51], s97 offen offset:0 sc1
    buffer_load_dwordx4 a[236:239], v5, s[48:51], s97 offen offset:1024 sc1
    s_waitcnt lgkmcnt(3)
    v_mfma_f32_32x32x16_bf16 v[16:31], a[168:171], v[100:103], v[16:31]
    ds_read_b128 v[84:87], v8 offset:25600
    v_mul_f32 v57, v57, v121
    v_mul_f32 v58, v58, v122
    v_mul_f32 v59, v59, v123
    v_mul_f32 v60, v60, v124
    v_mfma_f32_32x32x16_bf16 v[32:47], a[172:175], v[100:103], v[32:47]
    v_mul_f32 v61, v61, v125
    v_mul_f32 v62, v62, v126
    v_mul_f32 v63, v63, v127
    v_cvt_pk_bf16_f32 v128, v48, v49
    v_cvt_pk_bf16_f32 v129, v50, v51
    s_waitcnt lgkmcnt(3)
    v_mfma_f32_32x32x16_bf16 v[16:31], a[176:179], v[104:107], v[16:31]
    ds_read_b128 v[88:91], v8 offset:26624
    v_cvt_pk_bf16_f32 v130, v52, v53
    v_cvt_pk_bf16_f32 v131, v54, v55
    v_cvt_pk_bf16_f32 v132, v56, v57
    v_cvt_pk_bf16_f32 v133, v58, v59
    v_mfma_f32_32x32x16_bf16 v[32:47], a[180:183], v[104:107], v[32:47]
    v_cvt_pk_bf16_f32 v134, v60, v61
    v_cvt_pk_bf16_f32 v135, v62, v63
    v_lshlrev_b32 v48, 16, v128
    v_and_b32 v49, 0xffff0000, v128
    v_lshlrev_b32 v50, 16, v129
    s_waitcnt lgkmcnt(3)
    v_mfma_f32_32x32x16_bf16 v[16:31], a[184:187], v[108:111], v[16:31]
    ds_read_b128 v[92:95], v8 offset:27648
    v_and_b32 v51, 0xffff0000, v129
    v_lshlrev_b32 v52, 16, v130
    v_and_b32 v53, 0xffff0000, v130
    v_lshlrev_b32 v54, 16, v131
    v_mfma_f32_32x32x16_bf16 v[32:47], a[188:191], v[108:111], v[32:47]
    v_and_b32 v55, 0xffff0000, v131
    v_lshlrev_b32 v56, 16, v132
    v_and_b32 v57, 0xffff0000, v132
    v_lshlrev_b32 v58, 16, v133
    v_and_b32 v59, 0xffff0000, v133
    s_add_u32 s97, s96, 32768
    buffer_load_dwordx4 a[240:243], v5, s[48:51], s97 offen offset:0 sc1
    buffer_load_dwordx4 a[244:247], v5, s[48:51], s97 offen offset:1024 sc1
    s_waitcnt lgkmcnt(3)
    v_mfma_f32_32x32x16_bf16 v[16:31], a[192:195], v[80:83], v[16:31]
    s_waitcnt vmcnt(34)
    s_barrier
    ds_read_b128 v[96:99], v8 offset:28672
    v_lshlrev_b32 v60, 16, v134
    v_and_b32 v61, 0xffff0000, v134
    v_lshlrev_b32 v62, 16, v135
    v_and_b32 v63, 0xffff0000, v135
    v_mfma_f32_32x32x16_bf16 v[32:47], a[196:199], v[80:83], v[32:47]
    v_mul_f32 v48, v48, v64
    v_mul_f32 v49, v49, v65
    v_mul_f32 v50, v50, v66
    v_mul_f32 v51, v51, v67
    v_mul_f32 v52, v52, v68
    s_waitcnt lgkmcnt(3)
    v_mfma_f32_32x32x16_bf16 v[16:31], a[200:203], v[84:87], v[16:31]
    ds_read_b128 v[100:103], v8 offset:29696
    v_mul_f32 v53, v53, v69
    v_mul_f32 v54, v54, v70
    v_mul_f32 v55, v55, v71
    v_mul_f32 v56, v56, v72
    v_mfma_f32_32x32x16_bf16 v[32:47], a[204:207], v[84:87], v[32:47]
    v_mul_f32 v57, v57, v73
    v_mul_f32 v58, v58, v74
    v_mul_f32 v59, v59, v75
    v_mul_f32 v60, v60, v76
    v_mul_f32 v61, v61, v77
    s_waitcnt lgkmcnt(3)
    v_mfma_f32_32x32x16_bf16 v[16:31], a[208:211], v[88:91], v[16:31]
    ds_read_b128 v[104:107], v8 offset:30720
    v_mul_f32 v62, v62, v78
    v_mul_f32 v63, v63, v79
    v_cvt_pk_bf16_f32 v136, v48, v49
    v_cvt_pk_bf16_f32 v137, v50, v51
    v_mfma_f32_32x32x16_bf16 v[32:47], a[212:215], v[88:91], v[32:47]
    v_cvt_pk_bf16_f32 v138, v52, v53
    v_cvt_pk_bf16_f32 v139, v54, v55
    v_cvt_pk_bf16_f32 v140, v56, v57
    v_cvt_pk_bf16_f32 v141, v58, v59
    v_cvt_pk_bf16_f32 v142, v60, v61
    s_add_u32 s97, s96, 34816
    buffer_load_dwordx4 a[248:251], v5, s[48:51], s97 offen offset:0 sc1
    buffer_load_dwordx4 a[252:255], v5, s[48:51], s97 offen offset:1024 sc1
    s_waitcnt lgkmcnt(3)
    v_mfma_f32_32x32x16_bf16 v[16:31], a[216:219], v[92:95], v[16:31]
    ds_read_b128 v[108:111], v8 offset:31744
    v_cvt_pk_bf16_f32 v143, v62, v63
    s_mov_b32 s99, 114688
    buffer_store_dwordx4 v[136:139], v9, s[52:55], s99 offen sc1
    buffer_store_dwordx4 v[140:143], v9, s[52:55], s99 offen offset:1024 sc1
    v_mfma_f32_32x32x16_bf16 v[32:47], a[220:223], v[92:95], v[32:47]
    s_waitcnt lgkmcnt(3)
    v_mfma_f32_32x32x16_bf16 v[48:63], a[0:3], v[96:99], 0
    ds_read_b128 v[80:83], v8 offset:32768
    v_mfma_f32_32x32x16_bf16 v[64:79], a[4:7], v[96:99], 0
    s_waitcnt lgkmcnt(3)
    v_mfma_f32_32x32x16_bf16 v[48:63], a[8:11], v[100:103], v[48:63]
    ds_read_b128 v[84:87], v8 offset:33792
    v_mfma_f32_32x32x16_bf16 v[64:79], a[12:15], v[100:103], v[64:79]
    s_add_u32 s97, s96, 36864
    buffer_load_dwordx4 a[0:3], v5, s[48:51], s97 offen offset:0 sc1
    buffer_load_dwordx4 a[4:7], v5, s[48:51], s97 offen offset:1024 sc1
    s_waitcnt lgkmcnt(3)
    v_mfma_f32_32x32x16_bf16 v[48:63], a[16:19], v[104:107], v[48:63]
    ds_read_b128 v[88:91], v8 offset:34816
    v_mfma_f32_32x32x16_bf16 v[64:79], a[20:23], v[104:107], v[64:79]
    s_waitcnt lgkmcnt(3)
    v_mfma_f32_32x32x16_bf16 v[48:63], a[24:27], v[108:111], v[48:63]
    ds_read_b128 v[92:95], v8 offset:35840
    v_cvt_pk_bf16_f32 v128, v16, v17
    v_cvt_pk_bf16_f32 v129, v18, v19
    v_cvt_pk_bf16_f32 v130, v20, v21
    v_cvt_pk_bf16_f32 v131, v22, v23
    v_mfma_f32_32x32x16_bf16 v[64:79], a[28:31], v[108:111], v[64:79]
    v_cvt_pk_bf16_f32 v132, v24, v25
    v_cvt_pk_bf16_f32 v133, v26, v27
    v_cvt_pk_bf16_f32 v134, v28, v29
    v_cvt_pk_bf16_f32 v135, v30, v31
    v_lshlrev_b32 v16, 16, v128
    s_add_u32 s97, s96, 38912
    buffer_load_dwordx4 a[8:11], v5, s[48:51], s97 offen offset:0 sc1
    buffer_load_dwordx4 a[12:15], v5, s[48:51], s97 offen offset:1024 sc1
    s_waitcnt lgkmcnt(3)
    v_mfma_f32_32x32x16_bf16 v[48:63], a[32:35], v[80:83], v[48:63]
    ds_read_b128 v[96:99], v8 offset:36864
    v_and_b32 v17, 0xffff0000, v128
    v_lshlrev_b32 v18, 16, v129
    v_and_b32 v19, 0xffff0000, v129
    v_lshlrev_b32 v20, 16, v130
    v_mfma_f32_32x32x16_bf16 v[64:79], a[36:39], v[80:83], v[64:79]
    v_and_b32 v21, 0xffff0000, v130
    v_lshlrev_b32 v22, 16, v131
    v_and_b32 v23, 0xffff0000, v131
    v_lshlrev_b32 v24, 16, v132
    v_and_b32 v25, 0xffff0000, v132
    s_waitcnt lgkmcnt(3)
    v_mfma_f32_32x32x16_bf16 v[48:63], a[40:43], v[84:87], v[48:63]
    ds_read_b128 v[100:103], v8 offset:37888
    v_lshlrev_b32 v26, 16, v133
    v_and_b32 v27, 0xffff0000, v133
    v_lshlrev_b32 v28, 16, v134
    v_and_b32 v29, 0xffff0000, v134
    v_mfma_f32_32x32x16_bf16 v[64:79], a[44:47], v[84:87], v[64:79]
    v_lshlrev_b32 v30, 16, v135
    v_and_b32 v31, 0xffff0000, v135
    v_mul_f32 v112, s39, v16
    v_mul_f32 v113, s39, v17
    v_mul_f32 v114, s39, v18
    s_add_u32 s97, s96, 40960
    buffer_load_dwordx4 a[16:19], v5, s[48:51], s97 offen offset:0 sc1
    buffer_load_dwordx4 a[20:23], v5, s[48:51], s97 offen offset:1024 sc1
    s_waitcnt lgkmcnt(3)
    v_mfma_f32_32x32x16_bf16 v[48:63], a[48:51], v[88:91], v[48:63]
    ds_read_b128 v[104:107], v8 offset:38912
    v_mul_f32 v115, s39, v19
    v_mul_f32 v116, s39, v20
    v_mul_f32 v117, s39, v21
    v_mul_f32 v118, s39, v22
    v_mfma_f32_32x32x16_bf16 v[64:79], a[52:55], v[88:91], v[64:79]
    v_mul_f32 v119, s39, v23
    v_mul_f32 v120, s39, v24
    v_mul_f32 v121, s39, v25
    v_mul_f32 v122, s39, v26
    v_mul_f32 v123, s39, v27
    s_waitcnt lgkmcnt(3)
    v_mfma_f32_32x32x16_bf16 v[48:63], a[56:59], v[92:95], v[48:63]
    ds_read_b128 v[108:111], v8 offset:39936
    v_mul_f32 v124, s39, v28
    v_mul_f32 v125, s39, v29
    v_mul_f32 v126, s39, v30
    v_mul_f32 v127, s39, v31
    v_mfma_f32_32x32x16_bf16 v[64:79], a[60:63], v[92:95], v[64:79]
    v_exp_f32 v112, v112
    v_exp_f32 v113, v113
    s_add_u32 s97, s96, 43008
    buffer_load_dwordx4 a[24:27], v5, s[48:51], s97 offen offset:0 sc1
    buffer_load_dwordx4 a[28:31], v5, s[48:51], s97 offen offset:1024 sc1
    s_waitcnt lgkmcnt(3)
    v_mfma_f32_32x32x16_bf16 v[48:63], a[64:67], v[96:99], v[48:63]
    ds_read_b128 v[80:83], v8 offset:40960
    v_exp_f32 v114, v114
    v_exp_f32 v115, v115
    v_mfma_f32_32x32x16_bf16 v[64:79], a[68:71], v[96:99], v[64:79]
    v_exp_f32 v116, v116
    v_exp_f32 v117, v117
    s_waitcnt lgkmcnt(3)
    v_mfma_f32_32x32x16_bf16 v[48:63], a[72:75], v[100:103], v[48:63]
    ds_read_b128 v[84:87], v8 offset:41984
    v_exp_f32 v118, v118
    v_exp_f32 v119, v119
    v_mfma_f32_32x32x16_bf16 v[64:79], a[76:79], v[100:103], v[64:79]
    v_exp_f32 v120, v120
    v_exp_f32 v121, v121
    s_add_u32 s97, s96, 45056
    buffer_load_dwordx4 a[32:35], v5, s[48:51], s97 offen offset:0 sc1
    buffer_load_dwordx4 a[36:39], v5, s[48:51], s97 offen offset:1024 sc1
    s_waitcnt lgkmcnt(3)
    v_mfma_f32_32x32x16_bf16 v[48:63], a[80:83], v[104:107], v[48:63]
    ds_read_b128 v[88:91], v8 offset:43008
    v_exp_f32 v122, v122
    v_exp_f32 v123, v123
    v_mfma_f32_32x32x16_bf16 v[64:79], a[84:87], v[104:107], v[64:79]
    v_exp_f32 v124, v124
    v_exp_f32 v125, v125
    s_waitcnt lgkmcnt(3)
    v_mfma_f32_32x32x16_bf16 v[48:63], a[88:91], v[108:111], v[48:63]
    ds_read_b128 v[92:95], v8 offset:44032
    v_exp_f32 v126, v126
    v_exp_f32 v127, v127
    v_mfma_f32_32x32x16_bf16 v[64:79], a[92:95], v[108:111], v[64:79]
    v_cvt_pk_bf16_f32 v128, v32, v33
    v_cvt_pk_bf16_f32 v129, v34, v35
    v_cvt_pk_bf16_f32 v130, v36, v37
    v_cvt_pk_bf16_f32 v131, v38, v39
    v_cvt_pk_bf16_f32 v132, v40, v41
    s_add_u32 s97, s96, 47104
    buffer_load_dwordx4 a[40:43], v5, s[48:51], s97 offen offset:0 sc1
    buffer_load_dwordx4 a[44:47], v5, s[48:51], s97 offen offset:1024 sc1
    s_waitcnt lgkmcnt(3)
    v_mfma_f32_32x32x16_bf16 v[48:63], a[96:99], v[80:83], v[48:63]
    ds_read_b128 v[96:99], v8 offset:45056
    v_cvt_pk_bf16_f32 v133, v42, v43
    v_cvt_pk_bf16_f32 v134, v44, v45
    v_cvt_pk_bf16_f32 v135, v46, v47
    v_add_f32 v112, 1.0, v112
    v_mfma_f32_32x32x16_bf16 v[64:79], a[100:103], v[80:83], v[64:79]
    v_add_f32 v113, 1.0, v113
    v_add_f32 v114, 1.0, v114
    v_add_f32 v115, 1.0, v115
    v_add_f32 v116, 1.0, v116
    v_add_f32 v117, 1.0, v117
    s_waitcnt lgkmcnt(3)
    v_mfma_f32_32x32x16_bf16 v[48:63], a[104:107], v[84:87], v[48:63]
    ds_read_b128 v[100:103], v8 offset:46080
    v_add_f32 v118, 1.0, v118
    v_add_f32 v119, 1.0, v119
    v_add_f32 v120, 1.0, v120
    v_add_f32 v121, 1.0, v121
    v_mfma_f32_32x32x16_bf16 v[64:79], a[108:111], v[84:87], v[64:79]
    v_add_f32 v122, 1.0, v122
    v_add_f32 v123, 1.0, v123
    v_add_f32 v124, 1.0, v124
    v_add_f32 v125, 1.0, v125
    v_add_f32 v126, 1.0, v126
    s_add_u32 s97, s96, 49152
    buffer_load_dwordx4 a[48:51], v5, s[48:51], s97 offen offset:0 sc1
    buffer_load_dwordx4 a[52:55], v5, s[48:51], s97 offen offset:1024 sc1
    s_waitcnt lgkmcnt(3)
    v_mfma_f32_32x32x16_bf16 v[48:63], a[112:115], v[88:91], v[48:63]
    ds_read_b128 v[104:107], v8 offset:47104
    v_add_f32 v127, 1.0, v127
    v_rcp_f32 v112, v112
    v_mfma_f32_32x32x16_bf16 v[64:79], a[116:119], v[88:91], v[64:79]
    v_rcp_f32 v113, v113
    v_rcp_f32 v114, v114
    s_waitcnt lgkmcnt(3)
    v_mfma_f32_32x32x16_bf16 v[48:63], a[120:123], v[92:95], v[48:63]
    ds_read_b128 v[108:111], v8 offset:48128
    v_rcp_f32 v115, v115
    v_rcp_f32 v116, v116
    v_mfma_f32_32x32x16_bf16 v[64:79], a[124:127], v[92:95], v[64:79]
    v_rcp_f32 v117, v117
    v_rcp_f32 v118, v118
    s_add_u32 s97, s96, 51200
    buffer_load_dwordx4 a[56:59], v5, s[48:51], s97 offen offset:0 sc1
    buffer_load_dwordx4 a[60:63], v5, s[48:51], s97 offen offset:1024 sc1
    s_waitcnt lgkmcnt(3)
    v_mfma_f32_32x32x16_bf16 v[48:63], a[128:131], v[96:99], v[48:63]
    s_waitcnt vmcnt(16)
    s_barrier
    s_cmp_lg_u32 s32, 0
    s_cbranch_scc1 Lpub_25
    v_mov_b32 v1, 2
    s_mov_b64 exec, 1
    s_add_u32 s3, s10, 128
    v_mov_b32 v15, s3
    buffer_store_dword v1, v15, s[40:43], 0 offen sc1
    s_mov_b64 exec, -1
Lpub_25:
    ds_read_b128 v[80:83], v8 offset:49152
    v_rcp_f32 v119, v119
    v_rcp_f32 v120, v120
    v_mfma_f32_32x32x16_bf16 v[64:79], a[132:135], v[96:99], v[64:79]
    v_rcp_f32 v121, v121
    v_rcp_f32 v122, v122
    s_waitcnt lgkmcnt(3)
    v_mfma_f32_32x32x16_bf16 v[48:63], a[136:139], v[100:103], v[48:63]
    ds_read_b128 v[84:87], v8 offset:50176
    v_rcp_f32 v123, v123
    v_rcp_f32 v124, v124
    v_mfma_f32_32x32x16_bf16 v[64:79], a[140:143], v[100:103], v[64:79]
    v_rcp_f32 v125, v125
    v_rcp_f32 v126, v126
    s_add_u32 s97, s96, 53248
    buffer_load_dwordx4 a[64:67], v5, s[48:51], s97 offen offset:0 sc1
    buffer_load_dwordx4 a[68:71], v5, s[48:51], s97 offen offset:1024 sc1
    s_waitcnt lgkmcnt(3)
    v_mfma_f32_32x32x16_bf16 v[48:63], a[144:147], v[104:107], v[48:63]
    ds_read_b128 v[88:91], v8 offset:51200
    v_rcp_f32 v127, v127
    v_lshlrev_b32 v32, 16, v128
    v_and_b32 v33, 0xffff0000, v128
    v_mfma_f32_32x32x16_bf16 v[64:79], a[148:151], v[104:107], v[64:79]
    v_lshlrev_b32 v34, 16, v129
    v_and_b32 v35, 0xffff0000, v129
    v_lshlrev_b32 v36, 16, v130
    v_and_b32 v37, 0xffff0000, v130
    v_lshlrev_b32 v38, 16, v131
    s_waitcnt lgkmcnt(3)
    v_mfma_f32_32x32x16_bf16 v[48:63], a[152:155], v[108:111], v[48:63]
    ds_read_b128 v[92:95], v8 offset:52224
    v_and_b32 v39, 0xffff0000, v131
    v_lshlrev_b32 v40, 16, v132
    v_and_b32 v41, 0xffff0000, v132
    v_lshlrev_b32 v42, 16, v133
    v_mfma_f32_32x32x16_bf16 v[64:79], a[156:159], v[108:111], v[64:79]
    v_and_b32 v43, 0xffff0000, v133
    v_lshlrev_b32 v44, 16, v134
    v_and_b32 v45, 0xffff0000, v134
    v_lshlrev_b32 v46, 16, v135
    v_and_b32 v47, 0xffff0000, v135
    s_add_u32 s97, s96, 55296
    buffer_load_dwordx4 a[72:75], v5, s[48:51], s97 offen offset:0 sc1
    buffer_load_dwordx4 a[76:79], v5, s[48:51], s97 offen offset:1024 sc1
    s_waitcnt lgkmcnt(3)
    v_mfma_f32_32x32x16_bf16 v[48:63], a[160:163], v[80:83], v[48:63]
    ds_read_b128 v[96:99], v8 offset:53248
    v_mul_f32 v16, v16, v112
    v_mul_f32 v17, v17, v113
    v_mul_f32 v18, v18, v114
    v_mul_f32 v19, v19, v115
    v_mfma_f32_32x32x16_bf16 v[64:79], a[164:167], v[80:83], v[64:79]
    v_mul_f32 v20, v20, v116
    v_mul_f32 v21, v21, v117
    v_mul_f32 v22, v22, v118
    v_mul_f32 v23, v23, v119
    v_mul_f32 v24, v24, v120
    s_waitcnt lgkmcnt(3)
    v_mfma_f32_32x32x16_bf16 v[48:63], a[168:171], v[84:87], v[48:63]
    ds_read_b128 v[100:103], v8 offset:54272
    v_mul_f32 v25, v25, v121
    v_mul_f32 v26, v26, v122
    v_mul_f32 v27, v27, v123
    v_mul_f32 v28, v28, v124
    v_mfma_f32_32x32x16_bf16 v[64:79], a[172:175], v[84:87], v[64:79]
    v_mul_f32 v29, v29, v125
    v_mul_f32 v30, v30, v126
    v_mul_f32 v31, v31, v127
    v_cvt_pk_bf16_f32 v128, v16, v17
    v_cvt_pk_bf16_f32 v129, v18, v19
    s_waitcnt lgkmcnt(3)
    v_mfma_f32_32x32x16_bf16 v[48:63], a[176:179], v[88:91], v[48:63]
    ds_read_b128 v[104:107], v8 offset:55296
    v_cvt_pk_bf16_f32 v130, v20, v21
    v_cvt_pk_bf16_f32 v131, v22, v23
    v_cvt_pk_bf16_f32 v132, v24, v25
    v_cvt_pk_bf16_f32 v133, v26, v27
    v_mfma_f32_32x32x16_bf16 v[64:79], a[180:183], v[88:91], v[64:79]
    v_cvt_pk_bf16_f32 v134, v28, v29
    v_cvt_pk_bf16_f32 v135, v30, v31
    v_lshlrev_b32 v16, 16, v128
    v_and_b32 v17, 0xffff0000, v128
    v_lshlrev_b32 v18, 16, v129
    s_waitcnt lgkmcnt(3)
    v_mfma_f32_32x32x16_bf16 v[48:63], a[184:187], v[92:95], v[48:63]
    ds_read_b128 v[108:111], v8 offset:56320
    v_and_b32 v19, 0xffff0000, v129
    v_lshlrev_b32 v20, 16, v130
    v_and_b32 v21, 0xffff0000, v130
    v_lshlrev_b32 v22, 16, v131
    v_mfma_f32_32x32x16_bf16 v[64:79], a[188:191], v[92:95], v[64:79]
    v_and_b32 v23, 0xffff0000, v131
    v_lshlrev_b32 v24, 16, v132
    v_and_b32 v25, 0xffff0000, v132
    v_lshlrev_b32 v26, 16, v133
    v_and_b32 v27, 0xffff0000, v133
    s_waitcnt lgkmcnt(3)
    v_mfma_f32_32x32x16_bf16 v[48:63], a[192:195], v[96:99], v[48:63]
    v_lshlrev_b32 v28, 16, v134
    v_and_b32 v29, 0xffff0000, v134
    v_lshlrev_b32 v30, 16, v135
    v_and_b32 v31, 0xffff0000, v135
    v_mfma_f32_32x32x16_bf16 v[64:79], a[196:199], v[96:99], v[64:79]
    v_mul_f32 v16, v16, v32
    v_mul_f32 v17, v17, v33
    v_mul_f32 v18, v18, v34
    v_mul_f32 v19, v19, v35
    v_mul_f32 v20, v20, v36
    s_waitcnt lgkmcnt(2)
    v_mfma_f32_32x32x16_bf16 v[48:63], a[200:203], v[100:103], v[48:63]
    v_mul_f32 v21, v21, v37
    v_mul_f32 v22, v22, v38
    v_mul_f32 v23, v23, v39
    v_mul_f32 v24, v24, v40
    v_mfma_f32_32x32x16_bf16 v[64:79], a[204:207], v[100:103], v[64:79]
    v_mul_f32 v25, v25, v41
    v_mul_f32 v26, v26, v42
    v_mul_f32 v27, v27, v43
    v_mul_f32 v28, v28, v44
    v_mul_f32 v29, v29, v45
    s_waitcnt lgkmcnt(1)
    v_mfma_f32_32x32x16_bf16 v[48:63], a[208:211], v[104:107], v[48:63]
    v_mul_f32 v30, v30, v46
    v_mul_f32 v31, v31, v47
    v_cvt_pk_bf16_f32 v136, v16, v17
    v_cvt_pk_bf16_f32 v137, v18, v19
    v_mfma_f32_32x32x16_bf16 v[64:79], a[212:215], v[104:107], v[64:79]
    v_cvt_pk_bf16_f32 v138, v20, v21
    v_cvt_pk_bf16_f32 v139, v22, v23
    v_cvt_pk_bf16_f32 v140, v24, v25
    v_cvt_pk_bf16_f32 v141, v26, v27
    v_cvt_pk_bf16_f32 v142, v28, v29
    s_waitcnt lgkmcnt(0)
    v_mfma_f32_32x32x16_bf16 v[48:63], a[216:219], v[108:111], v[48:63]
    v_cvt_pk_bf16_f32 v143, v30, v31
    s_mov_b32 s99, 3670016
    buffer_store_dwordx4 v[136:139], v9, s[52:55], s99 offen sc1
    buffer_store_dwordx4 v[140:143], v9, s[52:55], s99 offen offset:1024 sc1
    v_mfma_f32_32x32x16_bf16 v[64:79], a[220:223], v[108:111], v[64:79]
    s_nop 11
    s_lshl_b32 s92, s33, 1
    s_add_u32 s92, s92, s34
    s_mul_i32 s93, s92, 114688
    s_mul_i32 s94, s32, 28672
    s_add_u32 s93, s93, s94
    s_add_u32 s94, s93, 3670016
    s_add_u32 s44, s30, 9437184
    s_addc_u32 s45, s31, 0
    s_mov_b32 s46, 7340032
    s_mov_b32 s47, 0x00020000
    v_cvt_pk_bf16_f32 v128, v48, v49
    v_cvt_pk_bf16_f32 v129, v50, v51
    v_cvt_pk_bf16_f32 v130, v52, v53
    v_cvt_pk_bf16_f32 v131, v54, v55
    v_cvt_pk_bf16_f32 v132, v56, v57
    v_cvt_pk_bf16_f32 v133, v58, v59
    v_cvt_pk_bf16_f32 v134, v60, v61
    v_cvt_pk_bf16_f32 v135, v62, v63
    v_lshlrev_b32 v48, 16, v128
    v_and_b32 v49, 0xffff0000, v128
    v_lshlrev_b32 v50, 16, v129
    v_and_b32 v51, 0xffff0000, v129
    v_lshlrev_b32 v52, 16, v130
    v_and_b32 v53, 0xffff0000, v130
    v_lshlrev_b32 v54, 16, v131
    v_and_b32 v55, 0xffff0000, v131
    v_lshlrev_b32 v56, 16, v132
    v_and_b32 v57, 0xffff0000, v132
    v_lshlrev_b32 v58, 16, v133
    v_and_b32 v59, 0xffff0000, v133
    v_lshlrev_b32 v60, 16, v134
    v_and_b32 v61, 0xffff0000, v134
    v_lshlrev_b32 v62, 16, v135
    v_and_b32 v63, 0xffff0000, v135
    v_mul_f32 v112, s39, v48
    v_mul_f32 v113, s39, v49
    v_mul_f32 v114, s39, v50
    v_mul_f32 v115, s39, v51
    v_mul_f32 v116, s39, v52
    v_mul_f32 v117, s39, v53
    v_mul_f32 v118, s39, v54
    v_mul_f32 v119, s39, v55
    v_mul_f32 v120, s39, v56
    v_mul_f32 v121, s39, v57
    v_mul_f32 v122, s39, v58
    v_mul_f32 v123, s39, v59
    v_mul_f32 v124, s39, v60
    v_mul_f32 v125, s39, v61
    v_mul_f32 v126, s39, v62
    v_mul_f32 v127, s39, v63
    v_exp_f32 v112, v112
    v_exp_f32 v113, v113
    v_exp_f32 v114, v114
    v_exp_f32 v115, v115
    v_exp_f32 v116, v116
    v_exp_f32 v117, v117
    v_exp_f32 v118, v118
    v_exp_f32 v119, v119
    v_exp_f32 v120, v120
    v_exp_f32 v121, v121
    v_exp_f32 v122, v122
    v_exp_f32 v123, v123
    v_exp_f32 v124, v124
    v_exp_f32 v125, v125
    v_exp_f32 v126, v126
    v_exp_f32 v127, v127
    v_cvt_pk_bf16_f32 v128, v64, v65
    v_cvt_pk_bf16_f32 v129, v66, v67
    v_cvt_pk_bf16_f32 v130, v68, v69
    v_cvt_pk_bf16_f32 v131, v70, v71
    v_cvt_pk_bf16_f32 v132, v72, v73
    v_cvt_pk_bf16_f32 v133, v74, v75
    v_cvt_pk_bf16_f32 v134, v76, v77
    v_cvt_pk_bf16_f32 v135, v78, v79
    v_add_f32 v112, 1.0, v112
    v_add_f32 v113, 1.0, v113
    v_add_f32 v114, 1.0, v114
    v_add_f32 v115, 1.0, v115
    v_add_f32 v116, 1.0, v116
    v_add_f32 v117, 1.0, v117
    v_add_f32 v118, 1.0, v118
    v_add_f32 v119, 1.0, v119
    v_add_f32 v120, 1.0, v120
    v_add_f32 v121, 1.0, v121
    v_add_f32 v122, 1.0, v122
    v_add_f32 v123, 1.0, v123
    v_add_f32 v124, 1.0, v124
    v_add_f32 v125, 1.0, v125
    v_add_f32 v126, 1.0, v126
    v_add_f32 v127, 1.0, v127
    v_rcp_f32 v112, v112
    v_rcp_f32 v113, v113
    v_rcp_f32 v114, v114
    v_rcp_f32 v115, v115
    v_rcp_f32 v116, v116
    v_rcp_f32 v117, v117
    v_rcp_f32 v118, v118
    v_rcp_f32 v119, v119
    v_rcp_f32 v120, v120
    v_rcp_f32 v121, v121
    v_rcp_f32 v122, v122
    v_rcp_f32 v123, v123
    v_rcp_f32 v124, v124
    v_rcp_f32 v125, v125
    v_rcp_f32 v126, v126
    v_rcp_f32 v127, v127
    v_lshlrev_b32 v64, 16, v128
    v_and_b32 v65, 0xffff0000, v128
    v_lshlrev_b32 v66, 16, v129
    v_and_b32 v67, 0xffff0000, v129
    v_lshlrev_b32 v68, 16, v130
    v_and_b32 v69, 0xffff0000, v130
    v_lshlrev_b32 v70, 16, v131
    v_and_b32 v71, 0xffff0000, v131
    v_lshlrev_b32 v72, 16, v132
    v_and_b32 v73, 0xffff0000, v132
    v_lshlrev_b32 v74, 16, v133
    v_and_b32 v75, 0xffff0000, v133
    v_lshlrev_b32 v76, 16, v134
    v_and_b32 v77, 0xffff0000, v134
    v_lshlrev_b32 v78, 16, v135
    v_and_b32 v79, 0xffff0000, v135
    v_mul_f32 v48, v48, v112
    v_mul_f32 v49, v49, v113
    v_mul_f32 v50, v50, v114
    v_mul_f32 v51, v51, v115
    v_mul_f32 v52, v52, v116
    v_mul_f32 v53, v53, v117
    v_mul_f32 v54, v54, v118
    v_mul_f32 v55, v55, v119
    v_mul_f32 v56, v56, v120
    v_mul_f32 v57, v57, v121
    v_mul_f32 v58, v58, v122
    v_mul_f32 v59, v59, v123
    v_mul_f32 v60, v60, v124
    v_mul_f32 v61, v61, v125
    v_mul_f32 v62, v62, v126
    v_mul_f32 v63, v63, v127
    v_cvt_pk_bf16_f32 v128, v48, v49
    v_cvt_pk_bf16_f32 v129, v50, v51
    v_cvt_pk_bf16_f32 v130, v52, v53
    v_cvt_pk_bf16_f32 v131, v54, v55
    v_cvt_pk_bf16_f32 v132, v56, v57
    v_cvt_pk_bf16_f32 v133, v58, v59
    v_cvt_pk_bf16_f32 v134, v60, v61
    v_cvt_pk_bf16_f32 v135, v62, v63
    v_lshlrev_b32 v48, 16, v128
    v_and_b32 v49, 0xffff0000, v128
    v_lshlrev_b32 v50, 16, v129
    v_and_b32 v51, 0xffff0000, v129
    v_lshlrev_b32 v52, 16, v130
    v_and_b32 v53, 0xffff0000, v130
    v_lshlrev_b32 v54, 16, v131
    v_and_b32 v55, 0xffff0000, v131
    v_lshlrev_b32 v56, 16, v132
    v_and_b32 v57, 0xffff0000, v132
    v_lshlrev_b32 v58, 16, v133
    v_and_b32 v59, 0xffff0000, v133
    v_lshlrev_b32 v60, 16, v134
    v_and_b32 v61, 0xffff0000, v134
    v_lshlrev_b32 v62, 16, v135
    v_and_b32 v63, 0xffff0000, v135
    v_mul_f32 v48, v48, v64
    v_mul_f32 v49, v49, v65
    v_mul_f32 v50, v50, v66
    v_mul_f32 v51, v51, v67
    v_mul_f32 v52, v52, v68
    v_mul_f32 v53, v53, v69
    v_mul_f32 v54, v54, v70
    v_mul_f32 v55, v55, v71
    v_mul_f32 v56, v56, v72
    v_mul_f32 v57, v57, v73
    v_mul_f32 v58, v58, v74
    v_mul_f32 v59, v59, v75
    v_mul_f32 v60, v60, v76
    v_mul_f32 v61, v61, v77
    v_mul_f32 v62, v62, v78
    v_mul_f32 v63, v63, v79
    v_cvt_pk_bf16_f32 v136, v48, v49
    v_cvt_pk_bf16_f32 v137, v50, v51
    v_cvt_pk_bf16_f32 v138, v52, v53
    v_cvt_pk_bf16_f32 v139, v54, v55
    v_cvt_pk_bf16_f32 v140, v56, v57
    v_cvt_pk_bf16_f32 v141, v58, v59
    v_cvt_pk_bf16_f32 v142, v60, v61
    v_cvt_pk_bf16_f32 v143, v62, v63
    s_mov_b32 s99, 3784704
    buffer_store_dwordx4 v[136:139], v9, s[52:55], s99 offen sc1
    buffer_store_dwordx4 v[140:143], v9, s[52:55], s99 offen offset:1024 sc1
    buffer_load_dword v13, v12, s[40:43], 0 offen sc1
    s_waitcnt vmcnt(0) lgkmcnt(0)
    s_barrier
    s_cmp_lg_u32 s32, 0
    s_cbranch_scc1 Lpub_26
    v_mov_b32 v1, 4
    s_mov_b64 exec, 1
    s_add_u32 s3, s10, 128
    v_mov_b32 v15, s3
    buffer_store_dword v1, v15, s[40:43], 0 offen sc1
    s_mov_b64 exec, -1
Lpub_26:
    s_waitcnt vmcnt(63)
    v_cmp_gt_u32 vcc, 2, v13
    s_cbranch_vccz Lsdn_28
    s_mov_b32 s3, 0
Lslp_27:
    buffer_load_dword v13, v12, s[40:43], 0 offen sc1
    s_waitcnt vmcnt(0)
    v_cmp_gt_u32 vcc, 2, v13
    s_cbranch_vccz Lsdn_28
    s_sleep 1
    s_add_u32 s3, s3, 1
    s_cmp_lt_u32 s3, 200000
    s_cbranch_scc1 Lslp_27
Lsdn_28:
    s_add_u32 s95, s93, 0
    buffer_load_dwordx4 a[80:83], v5, s[44:47], s95 offen offset:0 sc1
    s_add_u32 s95, s93, 0
    buffer_load_dwordx4 a[84:87], v5, s[44:47], s95 offen offset:1024 sc1
    s_add_u32 s95, s93, 0
    buffer_load_dwordx4 a[88:91], v5, s[44:47], s95 offen offset:2048 sc1
    s_add_u32 s95, s93, 0
    buffer_load_dwordx4 a[92:95], v5, s[44:47], s95 offen offset:3072 sc1
    s_add_u32 s95, s93, 4096
    buffer_load_dwordx4 a[96:99], v5, s[44:47], s95 offen offset:0 sc1
    s_add_u32 s95, s93, 4096
    buffer_load_dwordx4 a[100:103], v5, s[44:47], s95 offen offset:1024 sc1
    s_add_u32 s95, s93, 4096
    buffer_load_dwordx4 a[104:107], v5, s[44:47], s95 offen offset:2048 sc1
    s_add_u32 s95, s93, 4096
    buffer_load_dwordx4 a[108:111], v5, s[44:47], s95 offen offset:3072 sc1
    s_add_u32 s95, s93, 8192
    buffer_load_dwordx4 a[112:115], v5, s[44:47], s95 offen offset:0 sc1
    s_add_u32 s95, s93, 8192
    buffer_load_dwordx4 a[116:119], v5, s[44:47], s95 offen offset:1024 sc1
    s_add_u32 s95, s93, 8192
    buffer_load_dwordx4 a[120:123], v5, s[44:47], s95 offen offset:2048 sc1
    s_add_u32 s95, s93, 8192
    buffer_load_dwordx4 a[124:127], v5, s[44:47], s95 offen offset:3072 sc1
    s_add_u32 s95, s93, 12288
    buffer_load_dwordx4 a[128:131], v5, s[44:47], s95 offen offset:0 sc1
    s_add_u32 s95, s93, 12288
    buffer_load_dwordx4 a[132:135], v5, s[44:47], s95 offen offset:1024 sc1
    s_add_u32 s95, s93, 12288
    buffer_load_dwordx4 a[136:139], v5, s[44:47], s95 offen offset:2048 sc1
    s_add_u32 s95, s93, 12288
    buffer_load_dwordx4 a[140:143], v5, s[44:47], s95 offen offset:3072 sc1
    s_add_u32 s95, s93, 16384
    buffer_load_dwordx4 a[144:147], v5, s[44:47], s95 offen offset:0 sc1
    s_add_u32 s95, s93, 16384
    buffer_load_dwordx4 a[148:151], v5, s[44:47], s95 offen offset:1024 sc1
    s_add_u32 s95, s93, 16384
    buffer_load_dwordx4 a[152:155], v5, s[44:47], s95 offen offset:2048 sc1
    s_add_u32 s95, s93, 16384
    buffer_load_dwordx4 a[156:159], v5, s[44:47], s95 offen offset:3072 sc1
    s_add_u32 s95, s93, 20480
    buffer_load_dwordx4 a[160:163], v5, s[44:47], s95 offen offset:0 sc1
    s_add_u32 s95, s93, 20480
    buffer_load_dwordx4 a[164:167], v5, s[44:47], s95 offen offset:1024 sc1
    s_add_u32 s95, s93, 20480
    buffer_load_dwordx4 a[168:171], v5, s[44:47], s95 offen offset:2048 sc1
    s_add_u32 s95, s93, 20480
    buffer_load_dwordx4 a[172:175], v5, s[44:47], s95 offen offset:3072 sc1
    s_add_u32 s95, s93, 24576
    buffer_load_dwordx4 a[176:179], v5, s[44:47], s95 offen offset:0 sc1
    s_add_u32 s95, s93, 24576
    buffer_load_dwordx4 a[180:183], v5, s[44:47], s95 offen offset:1024 sc1
    s_add_u32 s95, s93, 24576
    buffer_load_dwordx4 a[184:187], v5, s[44:47], s95 offen offset:2048 sc1
    s_add_u32 s95, s93, 24576
    buffer_load_dwordx4 a[188:191], v5, s[44:47], s95 offen offset:3072 sc1
    v_lshrrev_b32 v8, 3, v0
    v_and_b32 v9, 7, v0
    s_lshl_b32 s97, s92, 5
    v_add_u32 v10, s97, v8
    v_mul_u32_u24 v10, 896, v10
    s_lshl_b32 s97, s35, 7
    v_lshl_add_u32 v11, v9, 4, s97
    v_add_u32 v10, v10, v11
    v_mul_u32_u24 v15, 272, v8
    v_lshl_add_u32 v15, v9, 5, v15
    v_and_b32 v1, 31, v0
    v_mul_u32_u24 v1, 272, v1
    v_bfe_u32 v14, v0, 5, 1
    v_lshl_add_u32 v14, v14, 4, v1
    s_mul_i32 s97, s32, 8704
    v_add_u32 v14, s97, v14
    s_add_u32 s48, s30, 5242880
    s_addc_u32 s49, s31, 0
    s_mov_b32 s50, 1835008
    s_mov_b32 s51, 0x00020000
    s_add_u32 s52, s30, 4194304
    s_addc_u32 s53, s31, 0
    s_mov_b32 s54, 5376
    s_mov_b32 s55, 0x00020000
    s_mov_b32 s56, s26
    s_mov_b32 s57, s27
    s_mov_b32 s58, 1835008
    s_mov_b32 s59, 0x00020000
    s_mov_b32 s98, 917504
    s_movk_i32 s97, 4480
    buffer_load_dwordx4 v[80:83], v10, s[48:51], 0 offen sc1
    buffer_load_dwordx4 v[88:91], v11, s[52:55], s97 offen
    buffer_load_dwordx4 v[84:87], v10, s[48:51], s98 offen sc1
    buffer_load_dword v13, v12, s[40:43], 0 offen sc1
    s_waitcnt vmcnt(31)
    v_mfma_f32_32x32x16_bf16 v[16:31], v[144:147], a[80:83], 0
    v_mfma_f32_32x32x16_bf16 v[32:47], v[148:151], a[80:83], 0
    s_waitcnt vmcnt(30)
    v_mfma_f32_32x32x16_bf16 v[16:31], v[152:155], a[84:87], v[16:31]
    v_mfma_f32_32x32x16_bf16 v[32:47], v[156:159], a[84:87], v[32:47]
    s_waitcnt vmcnt(29)
    v_mfma_f32_32x32x16_bf16 v[16:31], v[160:163], a[88:91], v[16:31]
    v_mfma_f32_32x32x16_bf16 v[32:47], v[164:167], a[88:91], v[32:47]
    s_waitcnt vmcnt(28)
    v_mfma_f32_32x32x16_bf16 v[16:31], v[168:171], a[92:95], v[16:31]
    v_mfma_f32_32x32x16_bf16 v[32:47], v[172:175], a[92:95], v[32:47]
    s_waitcnt vmcnt(27)
    v_mfma_f32_32x32x16_bf16 v[16:31], v[176:179], a[96:99], v[16:31]
    v_mfma_f32_32x32x16_bf16 v[32:47], v[180:183], a[96:99], v[32:47]
    s_waitcnt vmcnt(26)
    v_mfma_f32_32x32x16_bf16 v[16:31], v[184:187], a[100:103], v[16:31]
    v_mfma_f32_32x32x16_bf16 v[32:47], v[188:191], a[100:103], v[32:47]
    s_waitcnt vmcnt(25)
    v_mfma_f32_32x32x16_bf16 v[16:31], v[192:195], a[104:107], v[16:31]
    v_mfma_f32_32x32x16_bf16 v[32:47], v[196:199], a[104:107], v[32:47]
    s_waitcnt vmcnt(24)
    v_mfma_f32_32x32x16_bf16 v[16:31], v[200:203], a[108:111], v[16:31]
    v_mfma_f32_32x32x16_bf16 v[32:47], v[204:207], a[108:111], v[32:47]
    s_waitcnt vmcnt(23)
    v_mfma_f32_32x32x16_bf16 v[16:31], v[208:211], a[112:115], v[16:31]
    v_mfma_f32_32x32x16_bf16 v[32:47], v[212:215], a[112:115], v[32:47]
    s_waitcnt vmcnt(22)
    v_mfma_f32_32x32x16_bf16 v[16:31], v[216:219], a[116:119], v[16:31]
    v_mfma_f32_32x32x16_bf16 v[32:47], v[220:223], a[116:119], v[32:47]
    s_waitcnt vmcnt(21)
    v_mfma_f32_32x32x16_bf16 v[16:31], v[224:227], a[120:123], v[16:31]
    v_mfma_f32_32x32x16_bf16 v[32:47], v[228:231], a[120:123], v[32:47]
    s_waitcnt vmcnt(20)
    v_mfma_f32_32x32x16_bf16 v[16:31], v[232:235], a[124:127], v[16:31]
    v_mfma_f32_32x32x16_bf16 v[32:47], v[236:239], a[124:127], v[32:47]
    s_waitcnt vmcnt(19)
    v_mfma_f32_32x32x16_bf16 v[16:31], v[240:243], a[128:131], v[16:31]
    v_mfma_f32_32x32x16_bf16 v[32:47], v[244:247], a[128:131], v[32:47]
    s_waitcnt vmcnt(18)
    v_mfma_f32_32x32x16_bf16 v[16:31], v[248:251], a[132:135], v[16:31]
    v_mfma_f32_32x32x16_bf16 v[32:47], v[252:255], a[132:135], v[32:47]
    s_waitcnt vmcnt(17)
    v_mfma_f32_32x32x16_bf16 v[16:31], a[224:227], a[136:139], v[16:31]
    v_mfma_f32_32x32x16_bf16 v[32:47], a[228:231], a[136:139], v[32:47]
    s_waitcnt vmcnt(16)
    v_mfma_f32_32x32x16_bf16 v[16:31], a[232:235], a[140:143], v[16:31]
    v_mfma_f32_32x32x16_bf16 v[32:47], a[236:239], a[140:143], v[32:47]
    s_waitcnt vmcnt(15)
    v_mfma_f32_32x32x16_bf16 v[16:31], a[240:243], a[144:147], v[16:31]
    v_mfma_f32_32x32x16_bf16 v[32:47], a[244:247], a[144:147], v[32:47]
    s_waitcnt vmcnt(14)
    v_mfma_f32_32x32x16_bf16 v[16:31], a[248:251], a[148:151], v[16:31]
    v_mfma_f32_32x32x16_bf16 v[32:47], a[252:255], a[148:151], v[32:47]
    s_waitcnt vmcnt(13)
    v_mfma_f32_32x32x16_bf16 v[16:31], a[0:3], a[152:155], v[16:31]
    v_mfma_f32_32x32x16_bf16 v[32:47], a[4:7], a[152:155], v[32:47]
    s_waitcnt vmcnt(12)
    v_mfma_f32_32x32x16_bf16 v[16:31], a[8:11], a[156:159], v[16:31]
    v_mfma_f32_32x32x16_bf16 v[32:47], a[12:15], a[156:159], v[32:47]
    s_waitcnt vmcnt(11)
    v_mfma_f32_32x32x16_bf16 v[16:31], a[16:19], a[160:163], v[16:31]
    v_mfma_f32_32x32x16_bf16 v[32:47], a[20:23], a[160:163], v[32:47]
    s_waitcnt vmcnt(10)
    v_mfma_f32_32x32x16_bf16 v[16:31], a[24:27], a[164:167], v[16:31]
    v_mfma_f32_32x32x16_bf16 v[32:47], a[28:31], a[164:167], v[32:47]
    s_waitcnt vmcnt(9)
    v_mfma_f32_32x32x16_bf16 v[16:31], a[32:35], a[168:171], v[16:31]
    v_mfma_f32_32x32x16_bf16 v[32:47], a[36:39], a[168:171], v[32:47]
    s_waitcnt vmcnt(8)
    v_mfma_f32_32x32x16_bf16 v[16:31], a[40:43], a[172:175], v[16:31]
    v_mfma_f32_32x32x16_bf16 v[32:47], a[44:47], a[172:175], v[32:47]
    s_waitcnt vmcnt(7)
    v_mfma_f32_32x32x16_bf16 v[16:31], a[48:51], a[176:179], v[16:31]
    v_mfma_f32_32x32x16_bf16 v[32:47], a[52:55], a[176:179], v[32:47]
    s_waitcnt vmcnt(6)
    v_mfma_f32_32x32x16_bf16 v[16:31], a[56:59], a[180:183], v[16:31]
    v_mfma_f32_32x32x16_bf16 v[32:47], a[60:63], a[180:183], v[32:47]
    s_waitcnt vmcnt(5)
    v_mfma_f32_32x32x16_bf16 v[16:31], a[64:67], a[184:187], v[16:31]
    v_mfma_f32_32x32x16_bf16 v[32:47], a[68:71], a[184:187], v[32:47]
    s_waitcnt vmcnt(4)
    v_mfma_f32_32x32x16_bf16 v[16:31], a[72:75], a[188:191], v[16:31]
    v_mfma_f32_32x32x16_bf16 v[32:47], a[76:79], a[188:191], v[32:47]
    s_waitcnt vmcnt(0)
    v_cmp_gt_u32 vcc, 4, v13
    s_cbranch_vccz Lsdn_30
    s_mov_b32 s3, 0
Lslp_29:
    buffer_load_dword v13, v12, s[40:43], 0 offen sc1
    s_waitcnt vmcnt(0)
    v_cmp_gt_u32 vcc, 4, v13
    s_cbranch_vccz Lsdn_30
    s_sleep 1
    s_add_u32 s3, s3, 1
    s_cmp_lt_u32 s3, 200000
    s_cbranch_scc1 Lslp_29
Lsdn_30:
    s_add_u32 s95, s94, 0
    buffer_load_dwordx4 a[80:83], v5, s[44:47], s95 offen offset:0 sc1
    s_add_u32 s95, s94, 0
    buffer_load_dwordx4 a[84:87], v5, s[44:47], s95 offen offset:1024 sc1
    s_add_u32 s95, s94, 0
    buffer_load_dwordx4 a[88:91], v5, s[44:47], s95 offen offset:2048 sc1
    s_add_u32 s95, s94, 0
    buffer_load_dwordx4 a[92:95], v5, s[44:47], s95 offen offset:3072 sc1
    s_add_u32 s95, s94, 4096
    buffer_load_dwordx4 a[96:99], v5, s[44:47], s95 offen offset:0 sc1
    s_add_u32 s95, s94, 4096
    buffer_load_dwordx4 a[100:103], v5, s[44:47], s95 offen offset:1024 sc1
    s_add_u32 s95, s94, 4096
    buffer_load_dwordx4 a[104:107], v5, s[44:47], s95 offen offset:2048 sc1
    s_add_u32 s95, s94, 4096
    buffer_load_dwordx4 a[108:111], v5, s[44:47], s95 offen offset:3072 sc1
    s_add_u32 s95, s94, 8192
    buffer_load_dwordx4 a[112:115], v5, s[44:47], s95 offen offset:0 sc1
    s_add_u32 s95, s94, 8192
    buffer_load_dwordx4 a[116:119], v5, s[44:47], s95 offen offset:1024 sc1
    s_add_u32 s95, s94, 8192
    buffer_load_dwordx4 a[120:123], v5, s[44:47], s95 offen offset:2048 sc1
    s_add_u32 s95, s94, 8192
    buffer_load_dwordx4 a[124:127], v5, s[44:47], s95 offen offset:3072 sc1
    s_add_u32 s95, s94, 12288
    buffer_load_dwordx4 a[128:131], v5, s[44:47], s95 offen offset:0 sc1
    s_add_u32 s95, s94, 12288
    buffer_load_dwordx4 a[132:135], v5, s[44:47], s95 offen offset:1024 sc1
    s_add_u32 s95, s94, 12288
    buffer_load_dwordx4 a[136:139], v5, s[44:47], s95 offen offset:2048 sc1
    s_add_u32 s95, s94, 12288
    buffer_load_dwordx4 a[140:143], v5, s[44:47], s95 offen offset:3072 sc1
    s_add_u32 s95, s94, 16384
    buffer_load_dwordx4 a[144:147], v5, s[44:47], s95 offen offset:0 sc1
    s_add_u32 s95, s94, 16384
    buffer_load_dwordx4 a[148:151], v5, s[44:47], s95 offen offset:1024 sc1
    s_add_u32 s95, s94, 16384
    buffer_load_dwordx4 a[152:155], v5, s[44:47], s95 offen offset:2048 sc1
    s_add_u32 s95, s94, 16384
    buffer_load_dwordx4 a[156:159], v5, s[44:47], s95 offen offset:3072 sc1
    s_add_u32 s95, s94, 20480
    buffer_load_dwordx4 a[160:163], v5, s[44:47], s95 offen offset:0 sc1
    s_add_u32 s95, s94, 20480
    buffer_load_dwordx4 a[164:167], v5, s[44:47], s95 offen offset:1024 sc1
    s_add_u32 s95, s94, 20480
    buffer_load_dwordx4 a[168:171], v5, s[44:47], s95 offen offset:2048 sc1
    s_add_u32 s95, s94, 20480
    buffer_load_dwordx4 a[172:175], v5, s[44:47], s95 offen offset:3072 sc1
    s_add_u32 s95, s94, 24576
    buffer_load_dwordx4 a[176:179], v5, s[44:47], s95 offen offset:0 sc1
    s_add_u32 s95, s94, 24576
    buffer_load_dwordx4 a[180:183], v5, s[44:47], s95 offen offset:1024 sc1
    s_add_u32 s95, s94, 24576
    buffer_load_dwordx4 a[184:187], v5, s[44:47], s95 offen offset:2048 sc1
    s_add_u32 s95, s94, 24576
    buffer_load_dwordx4 a[188:191], v5, s[44:47], s95 offen offset:3072 sc1
    ds_write_b128 v14, v[16:19] offset:0
    ds_write_b128 v14, v[20:23] offset:32
    ds_write_b128 v14, v[24:27] offset:64
    ds_write_b128 v14, v[28:31] offset:96
    ds_write_b128 v14, v[32:35] offset:128
    ds_write_b128 v14, v[36:39] offset:160
    ds_write_b128 v14, v[40:43] offset:192
    ds_write_b128 v14, v[44:47] offset:224
    s_waitcnt vmcnt(29)
    v_lshlrev_b32 v136, 16, v88
    v_and_b32 v137, 0xffff0000, v88
    v_lshlrev_b32 v138, 16, v89
    v_and_b32 v139, 0xffff0000, v89
    v_lshlrev_b32 v140, 16, v90
    v_and_b32 v141, 0xffff0000, v90
    v_lshlrev_b32 v142, 16, v91
    v_and_b32 v143, 0xffff0000, v91
    v_lshlrev_b32 v128, 16, v80
    v_and_b32 v129, 0xffff0000, v80
    v_lshlrev_b32 v130, 16, v81
    v_and_b32 v131, 0xffff0000, v81
    v_lshlrev_b32 v132, 16, v82
    v_and_b32 v133, 0xffff0000, v82
    v_lshlrev_b32 v134, 16, v83
    v_and_b32 v135, 0xffff0000, v83
    s_waitcnt lgkmcnt(0)
    s_barrier
    ds_read_b128 v[96:99], v15 offset:0
    ds_read_b128 v[100:103], v15 offset:16
    ds_read_b128 v[104:107], v15 offset:8704
    ds_read_b128 v[108:111], v15 offset:8720
    ds_read_b128 v[112:115], v15 offset:17408
    ds_read_b128 v[116:119], v15 offset:17424
    ds_read_b128 v[120:123], v15 offset:26112
    ds_read_b128 v[124:127], v15 offset:26128
    s_waitcnt lgkmcnt(4)
    v_pk_add_f32 v[96:97], v[96:97], v[104:105]
    v_pk_add_f32 v[98:99], v[98:99], v[106:107]
    v_pk_add_f32 v[100:101], v[100:101], v[108:109]
    v_pk_add_f32 v[102:103], v[102:103], v[110:111]
    s_waitcnt lgkmcnt(0)
    v_pk_add_f32 v[112:113], v[112:113], v[120:121]
    v_pk_add_f32 v[114:115], v[114:115], v[122:123]
    v_pk_add_f32 v[116:117], v[116:117], v[124:125]
    v_pk_add_f32 v[118:119], v[118:119], v[126:127]
    v_pk_add_f32 v[96:97], v[96:97], v[112:113]
    v_pk_add_f32 v[98:99], v[98:99], v[114:115]
    v_pk_add_f32 v[100:101], v[100:101], v[116:117]
    v_pk_add_f32 v[102:103], v[102:103], v[118:119]
    v_cvt_pk_bf16_f32 v92, v96, v97
    v_cvt_pk_bf16_f32 v93, v98, v99
    v_cvt_pk_bf16_f32 v94, v100, v101
    v_cvt_pk_bf16_f32 v95, v102, v103
    v_lshlrev_b32 v96, 16, v92
    v_and_b32 v97, 0xffff0000, v92
    v_lshlrev_b32 v98, 16, v93
    v_and_b32 v99, 0xffff0000, v93
    v_lshlrev_b32 v100, 16, v94
    v_and_b32 v101, 0xffff0000, v94
    v_lshlrev_b32 v102, 16, v95
    v_and_b32 v103, 0xffff0000, v95
    v_pk_mul_f32 v[96:97], v[96:97], v[136:137]
    v_pk_mul_f32 v[98:99], v[98:99], v[138:139]
    v_pk_mul_f32 v[100:101], v[100:101], v[140:141]
    v_pk_mul_f32 v[102:103], v[102:103], v[142:143]
    v_cvt_pk_bf16_f32 v92, v96, v97
    v_cvt_pk_bf16_f32 v93, v98, v99
    v_cvt_pk_bf16_f32 v94, v100, v101
    v_cvt_pk_bf16_f32 v95, v102, v103
    v_lshlrev_b32 v96, 16, v92
    v_and_b32 v97, 0xffff0000, v92
    v_lshlrev_b32 v98, 16, v93
    v_and_b32 v99, 0xffff0000, v93
    v_lshlrev_b32 v100, 16, v94
    v_and_b32 v101, 0xffff0000, v94
    v_lshlrev_b32 v102, 16, v95
    v_and_b32 v103, 0xffff0000, v95
    v_pk_add_f32 v[96:97], v[96:97], v[128:129]
    v_pk_add_f32 v[98:99], v[98:99], v[130:131]
    v_pk_add_f32 v[100:101], v[100:101], v[132:133]
    v_pk_add_f32 v[102:103], v[102:103], v[134:135]
    v_cvt_pk_bf16_f32 v104, v96, v97
    v_cvt_pk_bf16_f32 v105, v98, v99
    v_cvt_pk_bf16_f32 v106, v100, v101
    v_cvt_pk_bf16_f32 v107, v102, v103
    buffer_store_dwordx4 v[104:107], v10, s[56:59], 0 offen
    s_waitcnt vmcnt(28)
    v_mfma_f32_32x32x16_bf16 v[48:63], v[144:147], a[80:83], 0
    v_mfma_f32_32x32x16_bf16 v[64:79], v[148:151], a[80:83], 0
    s_waitcnt vmcnt(27)
    v_mfma_f32_32x32x16_bf16 v[48:63], v[152:155], a[84:87], v[48:63]
    v_mfma_f32_32x32x16_bf16 v[64:79], v[156:159], a[84:87], v[64:79]
    s_waitcnt vmcnt(26)
    v_mfma_f32_32x32x16_bf16 v[48:63], v[160:163], a[88:91], v[48:63]
    v_mfma_f32_32x32x16_bf16 v[64:79], v[164:167], a[88:91], v[64:79]
    s_waitcnt vmcnt(25)
    v_mfma_f32_32x32x16_bf16 v[48:63], v[168:171], a[92:95], v[48:63]
    v_mfma_f32_32x32x16_bf16 v[64:79], v[172:175], a[92:95], v[64:79]
    s_waitcnt vmcnt(24)
    v_mfma_f32_32x32x16_bf16 v[48:63], v[176:179], a[96:99], v[48:63]
    v_mfma_f32_32x32x16_bf16 v[64:79], v[180:183], a[96:99], v[64:79]
    s_waitcnt vmcnt(23)
    v_mfma_f32_32x32x16_bf16 v[48:63], v[184:187], a[100:103], v[48:63]
    v_mfma_f32_32x32x16_bf16 v[64:79], v[188:191], a[100:103], v[64:79]
    s_waitcnt vmcnt(22)
    v_mfma_f32_32x32x16_bf16 v[48:63], v[192:195], a[104:107], v[48:63]
    v_mfma_f32_32x32x16_bf16 v[64:79], v[196:199], a[104:107], v[64:79]
    s_waitcnt vmcnt(21)
    v_mfma_f32_32x32x16_bf16 v[48:63], v[200:203], a[108:111], v[48:63]
    v_mfma_f32_32x32x16_bf16 v[64:79], v[204:207], a[108:111], v[64:79]
    s_waitcnt vmcnt(20)
    v_mfma_f32_32x32x16_bf16 v[48:63], v[208:211], a[112:115], v[48:63]
    v_mfma_f32_32x32x16_bf16 v[64:79], v[212:215], a[112:115], v[64:79]
    s_waitcnt vmcnt(19)
    v_mfma_f32_32x32x16_bf16 v[48:63], v[216:219], a[116:119], v[48:63]
    v_mfma_f32_32x32x16_bf16 v[64:79], v[220:223], a[116:119], v[64:79]
    s_waitcnt vmcnt(18)
    v_mfma_f32_32x32x16_bf16 v[48:63], v[224:227], a[120:123], v[48:63]
    v_mfma_f32_32x32x16_bf16 v[64:79], v[228:231], a[120:123], v[64:79]
    s_waitcnt vmcnt(17)
    v_mfma_f32_32x32x16_bf16 v[48:63], v[232:235], a[124:127], v[48:63]
    v_mfma_f32_32x32x16_bf16 v[64:79], v[236:239], a[124:127], v[64:79]
    s_waitcnt vmcnt(16)
    v_mfma_f32_32x32x16_bf16 v[48:63], v[240:243], a[128:131], v[48:63]
    v_mfma_f32_32x32x16_bf16 v[64:79], v[244:247], a[128:131], v[64:79]
    s_waitcnt vmcnt(15)
    v_mfma_f32_32x32x16_bf16 v[48:63], v[248:251], a[132:135], v[48:63]
    v_mfma_f32_32x32x16_bf16 v[64:79], v[252:255], a[132:135], v[64:79]
    s_waitcnt vmcnt(14)
    v_mfma_f32_32x32x16_bf16 v[48:63], a[224:227], a[136:139], v[48:63]
    v_mfma_f32_32x32x16_bf16 v[64:79], a[228:231], a[136:139], v[64:79]
    s_waitcnt vmcnt(13)
    v_mfma_f32_32x32x16_bf16 v[48:63], a[232:235], a[140:143], v[48:63]
    v_mfma_f32_32x32x16_bf16 v[64:79], a[236:239], a[140:143], v[64:79]
    s_waitcnt vmcnt(12)
    v_mfma_f32_32x32x16_bf16 v[48:63], a[240:243], a[144:147], v[48:63]
    v_mfma_f32_32x32x16_bf16 v[64:79], a[244:247], a[144:147], v[64:79]
    s_waitcnt vmcnt(11)
    v_mfma_f32_32x32x16_bf16 v[48:63], a[248:251], a[148:151], v[48:63]
    v_mfma_f32_32x32x16_bf16 v[64:79], a[252:255], a[148:151], v[64:79]
    s_waitcnt vmcnt(10)
    v_mfma_f32_32x32x16_bf16 v[48:63], a[0:3], a[152:155], v[48:63]
    v_mfma_f32_32x32x16_bf16 v[64:79], a[4:7], a[152:155], v[64:79]
    s_waitcnt vmcnt(9)
    v_mfma_f32_32x32x16_bf16 v[48:63], a[8:11], a[156:159], v[48:63]
    v_mfma_f32_32x32x16_bf16 v[64:79], a[12:15], a[156:159], v[64:79]
    s_waitcnt vmcnt(8)
    v_mfma_f32_32x32x16_bf16 v[48:63], a[16:19], a[160:163], v[48:63]
    v_mfma_f32_32x32x16_bf16 v[64:79], a[20:23], a[160:163], v[64:79]
    s_waitcnt vmcnt(7)
    v_mfma_f32_32x32x16_bf16 v[48:63], a[24:27], a[164:167], v[48:63]
    v_mfma_f32_32x32x16_bf16 v[64:79], a[28:31], a[164:167], v[64:79]
    s_waitcnt vmcnt(6)
    v_mfma_f32_32x32x16_bf16 v[48:63], a[32:35], a[168:171], v[48:63]
    v_mfma_f32_32x32x16_bf16 v[64:79], a[36:39], a[168:171], v[64:79]
    s_waitcnt vmcnt(5)
    v_mfma_f32_32x32x16_bf16 v[48:63], a[40:43], a[172:175], v[48:63]
    v_mfma_f32_32x32x16_bf16 v[64:79], a[44:47], a[172:175], v[64:79]
    s_waitcnt vmcnt(4)
    v_mfma_f32_32x32x16_bf16 v[48:63], a[48:51], a[176:179], v[48:63]
    v_mfma_f32_32x32x16_bf16 v[64:79], a[52:55], a[176:179], v[64:79]
    s_waitcnt vmcnt(3)
    v_mfma_f32_32x32x16_bf16 v[48:63], a[56:59], a[180:183], v[48:63]
    v_mfma_f32_32x32x16_bf16 v[64:79], a[60:63], a[180:183], v[64:79]
    s_waitcnt vmcnt(2)
    v_mfma_f32_32x32x16_bf16 v[48:63], a[64:67], a[184:187], v[48:63]
    v_mfma_f32_32x32x16_bf16 v[64:79], a[68:71], a[184:187], v[64:79]
    s_waitcnt vmcnt(1)
    v_mfma_f32_32x32x16_bf16 v[48:63], a[72:75], a[188:191], v[48:63]
    v_mfma_f32_32x32x16_bf16 v[64:79], a[76:79], a[188:191], v[64:79]
    s_nop 11
    ds_write_b128 v14, v[48:51] offset:34816
    ds_write_b128 v14, v[52:55] offset:34848
    ds_write_b128 v14, v[56:59] offset:34880
    ds_write_b128 v14, v[60:63] offset:34912
    ds_write_b128 v14, v[64:67] offset:34944
    ds_write_b128 v14, v[68:71] offset:34976
    ds_write_b128 v14, v[72:75] offset:35008
    ds_write_b128 v14, v[76:79] offset:35040
    v_lshlrev_b32 v128, 16, v84
    v_and_b32 v129, 0xffff0000, v84
    v_lshlrev_b32 v130, 16, v85
    v_and_b32 v131, 0xffff0000, v85
    v_lshlrev_b32 v132, 16, v86
    v_and_b32 v133, 0xffff0000, v86
    v_lshlrev_b32 v134, 16, v87
    v_and_b32 v135, 0xffff0000, v87
    s_waitcnt lgkmcnt(0)
    s_barrier
    ds_read_b128 v[96:99], v15 offset:34816
    ds_read_b128 v[100:103], v15 offset:34832
    ds_read_b128 v[104:107], v15 offset:43520
    ds_read_b128 v[108:111], v15 offset:43536
    ds_read_b128 v[112:115], v15 offset:52224
    ds_read_b128 v[116:119], v15 offset:52240
    ds_read_b128 v[120:123], v15 offset:60928
    ds_read_b128 v[124:127], v15 offset:60944
    s_waitcnt lgkmcnt(4)
    v_pk_add_f32 v[96:97], v[96:97], v[104:105]
    v_pk_add_f32 v[98:99], v[98:99], v[106:107]
    v_pk_add_f32 v[100:101], v[100:101], v[108:109]
    v_pk_add_f32 v[102:103], v[102:103], v[110:111]
    s_waitcnt lgkmcnt(0)
    v_pk_add_f32 v[112:113], v[112:113], v[120:121]
    v_pk_add_f32 v[114:115], v[114:115], v[122:123]
    v_pk_add_f32 v[116:117], v[116:117], v[124:125]
    v_pk_add_f32 v[118:119], v[118:119], v[126:127]
    v_pk_add_f32 v[96:97], v[96:97], v[112:113]
    v_pk_add_f32 v[98:99], v[98:99], v[114:115]
    v_pk_add_f32 v[100:101], v[100:101], v[116:117]
    v_pk_add_f32 v[102:103], v[102:103], v[118:119]
    v_cvt_pk_bf16_f32 v92, v96, v97
    v_cvt_pk_bf16_f32 v93, v98, v99
    v_cvt_pk_bf16_f32 v94, v100, v101
    v_cvt_pk_bf16_f32 v95, v102, v103
    v_lshlrev_b32 v96, 16, v92
    v_and_b32 v97, 0xffff0000, v92
    v_lshlrev_b32 v98, 16, v93
    v_and_b32 v99, 0xffff0000, v93
    v_lshlrev_b32 v100, 16, v94
    v_and_b32 v101, 0xffff0000, v94
    v_lshlrev_b32 v102, 16, v95
    v_and_b32 v103, 0xffff0000, v95
    v_pk_mul_f32 v[96:97], v[96:97], v[136:137]
    v_pk_mul_f32 v[98:99], v[98:99], v[138:139]
    v_pk_mul_f32 v[100:101], v[100:101], v[140:141]
    v_pk_mul_f32 v[102:103], v[102:103], v[142:143]
    v_cvt_pk_bf16_f32 v92, v96, v97
    v_cvt_pk_bf16_f32 v93, v98, v99
    v_cvt_pk_bf16_f32 v94, v100, v101
    v_cvt_pk_bf16_f32 v95, v102, v103
    v_lshlrev_b32 v96, 16, v92
    v_and_b32 v97, 0xffff0000, v92
    v_lshlrev_b32 v98, 16, v93
    v_and_b32 v99, 0xffff0000, v93
    v_lshlrev_b32 v100, 16, v94
    v_and_b32 v101, 0xffff0000, v94
    v_lshlrev_b32 v102, 16, v95
    v_and_b32 v103, 0xffff0000, v95
    v_pk_add_f32 v[96:97], v[96:97], v[128:129]
    v_pk_add_f32 v[98:99], v[98:99], v[130:131]
    v_pk_add_f32 v[100:101], v[100:101], v[132:133]
    v_pk_add_f32 v[102:103], v[102:103], v[134:135]
    v_cvt_pk_bf16_f32 v104, v96, v97
    v_cvt_pk_bf16_f32 v105, v98, v99
    v_cvt_pk_bf16_f32 v106, v100, v101
    v_cvt_pk_bf16_f32 v107, v102, v103
    buffer_store_dwordx4 v[104:107], v10, s[56:59], s98 offen
    s_endpgm
L_extra:
    s_waitcnt lgkmcnt(0)
    s_add_u32 s40, s30, 4718592
    s_addc_u32 s41, s31, 0
    s_mov_b32 s42, 38912
    s_mov_b32 s43, 0x00020000
    v_cmp_gt_u32 vcc, 224, v2
    s_mov_b64 s[6:7], vcc
    s_lshl_b32 s10, s33, 8
    s_and_b32 s3, s37, 15
    s_lshl_b32 s3, s3, 2
    s_add_u32 s10, s10, s3
    s_add_u32 s10, s10, 16384
    s_add_u32 s11, s34, 1
    s_lshl_b32 s8, s32, 10
    s_mul_i32 s9, s32, 14336
    s_lshl_b32 s3, s33, 10
    s_add_u32 s3, s3, 22528
    v_add_u32 v246, s3, v5
    s_lshl_b32 s3, s37, 2
    s_add_u32 s3, s3, 22528
    v_lshl_add_u32 v245, v2, 8, s3
    s_cmp_lg_u32 s32, 0
    s_cbranch_scc1 Lsn_31
    buffer_load_dwordx4 v[240:243], v246, s[40:43], 0 offen sc1
    s_mov_b64 exec, 0xffff
    buffer_load_dword v244, v245, s[40:43], 0 offen sc1
    s_mov_b64 exec, -1
Lsn_31:
    s_lshl_b32 s93, s32, 1
    s_add_u32 s92, s100, s93
    s_mul_i32 s93, s92, 896
    v_add_u32 v236, s93, v5
    s_mov_b32 s52, s4
    s_mov_b32 s53, s5
    s_mov_b32 s54, 1835008
    s_mov_b32 s55, 0x00020000
    buffer_load_dwordx4 v[208:211], v236, s[52:55], 0 offen offset:0
    buffer_load_dwordx4 v[212:215], v236, s[52:55], 0 offen offset:896
    s_cmp_lg_u32 s32, 0
    s_cbranch_scc1 Lnl_32
    s_sub_u32 s92, s36, 21
    s_cmp_ge_u32 s92, 8
    s_cbranch_scc1 Lnl_32
    s_mov_b32 s44, s28
    s_mov_b32 s45, s29
    s_mov_b32 s46, 256
    s_mov_b32 s47, 0x00020000
    s_mov_b32 s3, 0
Lll_33:
    buffer_load_dword v1, v2, s[44:47], 0 offen sc1
    s_waitcnt vmcnt(0)
    v_and_b32 v8, 0x01000000, v4
    v_or_b32 v1, v1, v8
    v_cmp_ne_u32 vcc, 0x01010101, v1
    s_cbranch_vccz Lld_34
    s_sleep 8
    s_add_u32 s3, s3, 1
    s_cmp_lt_u32 s3, 200000
    s_cbranch_scc1 Lll_33
Lld_34:
    s_mov_b32 exec_hi, 0
    v_lshrrev_b32 v8, 6, v2
    v_lshlrev_b32 v8, 8, v8
    v_and_b32 v1, 63, v2
    v_add_u32 v8, v8, v1
    s_lshl_b32 s3, s92, 9
    s_add_u32 s3, s3, 16576
    v_add_u32 v8, s3, v8
    v_mov_b32 v1, 1
    buffer_store_dword v1, v8, s[40:43], 0 offen sc1
    s_mov_b64 exec, -1
Lnl_32:
    s_cmp_ge_u32 s36, 21
    s_cbranch_scc1 Lng_35
    v_and_b32 v1, 15, v0
    v_lshrrev_b32 v8, 4, v0
    v_mul_u32_u24 v9, 5376, v8
    v_lshl_add_u32 v9, v1, 4, v9
    s_lshl_b32 s92, s36, 8
    v_add_u32 v9, s92, v9
    v_lshlrev_b32 v10, 1, v8
    s_mov_b32 s44, s22
    s_mov_b32 s45, s23
    s_mov_b32 s46, 896
    s_mov_b32 s47, 0x00020000
    s_mov_b32 s48, s24
    s_mov_b32 s49, s25
    s_mov_b32 s50, 2408448
    s_mov_b32 s51, 0x00020000
    s_add_u32 s52, s30, 4194304
    s_addc_u32 s53, s31, 0
    s_mov_b32 s54, 5376
    s_mov_b32 s55, 0x00020000
    buffer_load_ushort v16, v10, s[44:47], 0 offen offset:0
    buffer_load_ushort v17, v10, s[44:47], 0 offen offset:32
    buffer_load_ushort v18, v10, s[44:47], 0 offen offset:64
    buffer_load_ushort v19, v10, s[44:47], 0 offen offset:96
    buffer_load_ushort v20, v10, s[44:47], 0 offen offset:128
    buffer_load_ushort v21, v10, s[44:47], 0 offen offset:160
    buffer_load_ushort v22, v10, s[44:47], 0 offen offset:192
    buffer_load_ushort v23, v10, s[44:47], 0 offen offset:224
    buffer_load_ushort v24, v10, s[44:47], 0 offen offset:256
    buffer_load_ushort v25, v10, s[44:47], 0 offen offset:288
    buffer_load_ushort v26, v10, s[44:47], 0 offen offset:320
    buffer_load_ushort v27, v10, s[44:47], 0 offen offset:352
    buffer_load_ushort v28, v10, s[44:47], 0 offen offset:384
    buffer_load_ushort v29, v10, s[44:47], 0 offen offset:416
    buffer_load_ushort v30, v10, s[44:47], 0 offen offset:448
    buffer_load_ushort v31, v10, s[44:47], 0 offen offset:480
    buffer_load_ushort v32, v10, s[44:47], 0 offen offset:512
    buffer_load_ushort v33, v10, s[44:47], 0 offen offset:544
    buffer_load_ushort v34, v10, s[44:47], 0 offen offset:576
    buffer_load_ushort v35, v10, s[44:47], 0 offen offset:608
    buffer_load_ushort v36, v10, s[44:47], 0 offen offset:640
    buffer_load_ushort v37, v10, s[44:47], 0 offen offset:672
    buffer_load_ushort v38, v10, s[44:47], 0 offen offset:704
    buffer_load_ushort v39, v10, s[44:47], 0 offen offset:736
    buffer_load_ushort v40, v10, s[44:47], 0 offen offset:768
    buffer_load_ushort v41, v10, s[44:47], 0 offen offset:800
    buffer_load_ushort v42, v10, s[44:47], 0 offen offset:832
    buffer_load_ushort v43, v10, s[44:47], 0 offen offset:864
    s_mov_b32 s93, 0
    buffer_load_dwordx4 v[48:51], v9, s[48:51], s93 offen
    s_add_u32 s93, s93, 86016
    buffer_load_dwordx4 v[52:55], v9, s[48:51], s93 offen
    s_add_u32 s93, s93, 86016
    buffer_load_dwordx4 v[56:59], v9, s[48:51], s93 offen
    s_add_u32 s93, s93, 86016
    buffer_load_dwordx4 v[60:63], v9, s[48:51], s93 offen
    s_add_u32 s93, s93, 86016
    buffer_load_dwordx4 v[64:67], v9, s[48:51], s93 offen
    s_add_u32 s93, s93, 86016
    buffer_load_dwordx4 v[68:71], v9, s[48:51], s93 offen
    s_add_u32 s93, s93, 86016
    buffer_load_dwordx4 v[72:75], v9, s[48:51], s93 offen
    s_add_u32 s93, s93, 86016
    buffer_load_dwordx4 v[76:79], v9, s[48:51], s93 offen
    s_add_u32 s93, s93, 86016
    buffer_load_dwordx4 v[80:83], v9, s[48:51], s93 offen
    s_add_u32 s93, s93, 86016
    buffer_load_dwordx4 v[84:87], v9, s[48:51], s93 offen
    s_add_u32 s93, s93, 86016
    buffer_load_dwordx4 v[88:91], v9, s[48:51], s93 offen
    s_add_u32 s93, s93, 86016
    buffer_load_dwordx4 v[92:95], v9, s[48:51], s93 offen
    s_add_u32 s93, s93, 86016
    buffer_load_dwordx4 v[96:99], v9, s[48:51], s93 offen
    s_add_u32 s93, s93, 86016
    buffer_load_dwordx4 v[100:103], v9, s[48:51], s93 offen
    s_add_u32 s93, s93, 86016
    buffer_load_dwordx4 v[104:107], v9, s[48:51], s93 offen
    s_add_u32 s93, s93, 86016
    buffer_load_dwordx4 v[108:111], v9, s[48:51], s93 offen
    s_add_u32 s93, s93, 86016
    buffer_load_dwordx4 v[112:115], v9, s[48:51], s93 offen
    s_add_u32 s93, s93, 86016
    buffer_load_dwordx4 v[116:119], v9, s[48:51], s93 offen
    s_add_u32 s93, s93, 86016
    buffer_load_dwordx4 v[120:123], v9, s[48:51], s93 offen
    s_add_u32 s93, s93, 86016
    buffer_load_dwordx4 v[124:127], v9, s[48:51], s93 offen
    s_add_u32 s93, s93, 86016
    buffer_load_dwordx4 v[128:131], v9, s[48:51], s93 offen
    s_add_u32 s93, s93, 86016
    buffer_load_dwordx4 v[132:135], v9, s[48:51], s93 offen
    s_add_u32 s93, s93, 86016
    buffer_load_dwordx4 v[136:139], v9, s[48:51], s93 offen
    s_add_u32 s93, s93, 86016
    buffer_load_dwordx4 v[140:143], v9, s[48:51], s93 offen
    s_add_u32 s93, s93, 86016
    buffer_load_dwordx4 v[144:147], v9, s[48:51], s93 offen
    s_add_u32 s93, s93, 86016
    buffer_load_dwordx4 v[148:151], v9, s[48:51], s93 offen
    s_add_u32 s93, s93, 86016
    buffer_load_dwordx4 v[152:155], v9, s[48:51], s93 offen
    s_add_u32 s93, s93, 86016
    buffer_load_dwordx4 v[156:159], v9, s[48:51], s93 offen
    s_waitcnt vmcnt(28)
    s_mov_b32 s94, 0xbfb8aa3b
    v_lshlrev_b32 v16, 16, v16
    v_lshlrev_b32 v17, 16, v17
    v_lshlrev_b32 v18, 16, v18
    v_lshlrev_b32 v19, 16, v19
    v_lshlrev_b32 v20, 16, v20
    v_lshlrev_b32 v21, 16, v21
    v_lshlrev_b32 v22, 16, v22
    v_lshlrev_b32 v23, 16, v23
    v_lshlrev_b32 v24, 16, v24
    v_lshlrev_b32 v25, 16, v25
    v_lshlrev_b32 v26, 16, v26
    v_lshlrev_b32 v27, 16, v27
    v_lshlrev_b32 v28, 16, v28
    v_lshlrev_b32 v29, 16, v29
    v_lshlrev_b32 v30, 16, v30
    v_lshlrev_b32 v31, 16, v31
    v_lshlrev_b32 v32, 16, v32
    v_lshlrev_b32 v33, 16, v33
    v_lshlrev_b32 v34, 16, v34
    v_lshlrev_b32 v35, 16, v35
    v_lshlrev_b32 v36, 16, v36
    v_lshlrev_b32 v37, 16, v37
    v_lshlrev_b32 v38, 16, v38
    v_lshlrev_b32 v39, 16, v39
    v_lshlrev_b32 v40, 16, v40
    v_lshlrev_b32 v41, 16, v41
    v_lshlrev_b32 v42, 16, v42
    v_lshlrev_b32 v43, 16, v43
    v_mul_f32 v176, s94, v16
    v_mul_f32 v177, s94, v17
    v_mul_f32 v178, s94, v18
    v_mul_f32 v179, s94, v19
    v_mul_f32 v180, s94, v20
    v_mul_f32 v181, s94, v21
    v_mul_f32 v182, s94, v22
    v_mul_f32 v183, s94, v23
    v_mul_f32 v184, s94, v24
    v_mul_f32 v185, s94, v25
    v_mul_f32 v186, s94, v26
    v_mul_f32 v187, s94, v27
    v_mul_f32 v188, s94, v28
    v_mul_f32 v189, s94, v29
    v_mul_f32 v190, s94, v30
    v_mul_f32 v191, s94, v31
    v_mul_f32 v192, s94, v32
    v_mul_f32 v193, s94, v33
    v_mul_f32 v194, s94, v34
    v_mul_f32 v195, s94, v35
    v_mul_f32 v196, s94, v36
    v_mul_f32 v197, s94, v37
    v_mul_f32 v198, s94, v38
    v_mul_f32 v199, s94, v39
    v_mul_f32 v200, s94, v40
    v_mul_f32 v201, s94, v41
    v_mul_f32 v202, s94, v42
    v_mul_f32 v203, s94, v43
    v_exp_f32 v176, v176
    v_exp_f32 v177, v177
    v_exp_f32 v178, v178
    v_exp_f32 v179, v179
    v_exp_f32 v180, v180
    v_exp_f32 v181, v181
    v_exp_f32 v182, v182
    v_exp_f32 v183, v183
    v_exp_f32 v184, v184
    v_exp_f32 v185, v185
    v_exp_f32 v186, v186
    v_exp_f32 v187, v187
    v_exp_f32 v188, v188
    v_exp_f32 v189, v189
    v_exp_f32 v190, v190
    v_exp_f32 v191, v191
    v_exp_f32 v192, v192
    v_exp_f32 v193, v193
    v_exp_f32 v194, v194
    v_exp_f32 v195, v195
    v_exp_f32 v196, v196
    v_exp_f32 v197, v197
    v_exp_f32 v198, v198
    v_exp_f32 v199, v199
    v_exp_f32 v200, v200
    v_exp_f32 v201, v201
    v_exp_f32 v202, v202
    v_exp_f32 v203, v203
    v_add_f32 v176, 1.0, v176
    v_add_f32 v177, 1.0, v177
    v_add_f32 v178, 1.0, v178
    v_add_f32 v179, 1.0, v179
    v_add_f32 v180, 1.0, v180
    v_add_f32 v181, 1.0, v181
    v_add_f32 v182, 1.0, v182
    v_add_f32 v183, 1.0, v183
    v_add_f32 v184, 1.0, v184
    v_add_f32 v185, 1.0, v185
    v_add_f32 v186, 1.0, v186
    v_add_f32 v187, 1.0, v187
    v_add_f32 v188, 1.0, v188
    v_add_f32 v189, 1.0, v189
    v_add_f32 v190, 1.0, v190
    v_add_f32 v191, 1.0, v191
    v_add_f32 v192, 1.0, v192
    v_add_f32 v193, 1.0, v193
    v_add_f32 v194, 1.0, v194
    v_add_f32 v195, 1.0, v195
    v_add_f32 v196, 1.0, v196
    v_add_f32 v197, 1.0, v197
    v_add_f32 v198, 1.0, v198
    v_add_f32 v199, 1.0, v199
    v_add_f32 v200, 1.0, v200
    v_add_f32 v201, 1.0, v201
    v_add_f32 v202, 1.0, v202
    v_add_f32 v203, 1.0, v203
    v_rcp_f32 v176, v176
    v_rcp_f32 v177, v177
    v_rcp_f32 v178, v178
    v_rcp_f32 v179, v179
    v_rcp_f32 v180, v180
    v_rcp_f32 v181, v181
    v_rcp_f32 v182, v182
    v_rcp_f32 v183, v183
    v_rcp_f32 v184, v184
    v_rcp_f32 v185, v185
    v_rcp_f32 v186, v186
    v_rcp_f32 v187, v187
    v_rcp_f32 v188, v188
    v_rcp_f32 v189, v189
    v_rcp_f32 v190, v190
    v_rcp_f32 v191, v191
    v_rcp_f32 v192, v192
    v_rcp_f32 v193, v193
    v_rcp_f32 v194, v194
    v_rcp_f32 v195, v195
    v_rcp_f32 v196, v196
    v_rcp_f32 v197, v197
    v_rcp_f32 v198, v198
    v_rcp_f32 v199, v199
    v_rcp_f32 v200, v200
    v_rcp_f32 v201, v201
    v_rcp_f32 v202, v202
    v_rcp_f32 v203, v203
    v_mul_f32 v16, v16, v176
    v_mul_f32 v17, v17, v177
    v_mul_f32 v18, v18, v178
    v_mul_f32 v19, v19, v179
    v_mul_f32 v20, v20, v180
    v_mul_f32 v21, v21, v181
    v_mul_f32 v22, v22, v182
    v_mul_f32 v23, v23, v183
    v_mul_f32 v24, v24, v184
    v_mul_f32 v25, v25, v185
    v_mul_f32 v26, v26, v186
    v_mul_f32 v27, v27, v187
    v_mul_f32 v28, v28, v188
    v_mul_f32 v29, v29, v189
    v_mul_f32 v30, v30, v190
    v_mul_f32 v31, v31, v191
    v_mul_f32 v32, v32, v192
    v_mul_f32 v33, v33, v193
    v_mul_f32 v34, v34, v194
    v_mul_f32 v35, v35, v195
    v_mul_f32 v36, v36, v196
    v_mul_f32 v37, v37, v197
    v_mul_f32 v38, v38, v198
    v_mul_f32 v39, v39, v199
    v_mul_f32 v40, v40, v200
    v_mul_f32 v41, v41, v201
    v_mul_f32 v42, v42, v202
    v_mul_f32 v43, v43, v203
    v_cvt_pk_bf16_f32 v16, v16, v16
    v_cvt_pk_bf16_f32 v17, v17, v17
    v_cvt_pk_bf16_f32 v18, v18, v18
    v_cvt_pk_bf16_f32 v19, v19, v19
    v_cvt_pk_bf16_f32 v20, v20, v20
    v_cvt_pk_bf16_f32 v21, v21, v21
    v_cvt_pk_bf16_f32 v22, v22, v22
    v_cvt_pk_bf16_f32 v23, v23, v23
    v_cvt_pk_bf16_f32 v24, v24, v24
    v_cvt_pk_bf16_f32 v25, v25, v25
    v_cvt_pk_bf16_f32 v26, v26, v26
    v_cvt_pk_bf16_f32 v27, v27, v27
    v_cvt_pk_bf16_f32 v28, v28, v28
    v_cvt_pk_bf16_f32 v29, v29, v29
    v_cvt_pk_bf16_f32 v30, v30, v30
    v_cvt_pk_bf16_f32 v31, v31, v31
    v_cvt_pk_bf16_f32 v32, v32, v32
    v_cvt_pk_bf16_f32 v33, v33, v33
    v_cvt_pk_bf16_f32 v34, v34, v34
    v_cvt_pk_bf16_f32 v35, v35, v35
    v_cvt_pk_bf16_f32 v36, v36, v36
    v_cvt_pk_bf16_f32 v37, v37, v37
    v_cvt_pk_bf16_f32 v38, v38, v38
    v_cvt_pk_bf16_f32 v39, v39, v39
    v_cvt_pk_bf16_f32 v40, v40, v40
    v_cvt_pk_bf16_f32 v41, v41, v41
    v_cvt_pk_bf16_f32 v42, v42, v42
    v_cvt_pk_bf16_f32 v43, v43, v43
    v_lshlrev_b32 v16, 16, v16
    v_lshlrev_b32 v17, 16, v17
    v_lshlrev_b32 v18, 16, v18
    v_lshlrev_b32 v19, 16, v19
    v_lshlrev_b32 v20, 16, v20
    v_lshlrev_b32 v21, 16, v21
    v_lshlrev_b32 v22, 16, v22
    v_lshlrev_b32 v23, 16, v23
    v_lshlrev_b32 v24, 16, v24
    v_lshlrev_b32 v25, 16, v25
    v_lshlrev_b32 v26, 16, v26
    v_lshlrev_b32 v27, 16, v27
    v_lshlrev_b32 v28, 16, v28
    v_lshlrev_b32 v29, 16, v29
    v_lshlrev_b32 v30, 16, v30
    v_lshlrev_b32 v31, 16, v31
    v_lshlrev_b32 v32, 16, v32
    v_lshlrev_b32 v33, 16, v33
    v_lshlrev_b32 v34, 16, v34
    v_lshlrev_b32 v35, 16, v35
    v_lshlrev_b32 v36, 16, v36
    v_lshlrev_b32 v37, 16, v37
    v_lshlrev_b32 v38, 16, v38
    v_lshlrev_b32 v39, 16, v39
    v_lshlrev_b32 v40, 16, v40
    v_lshlrev_b32 v41, 16, v41
    v_lshlrev_b32 v42, 16, v42
    v_lshlrev_b32 v43, 16, v43
    v_mov_b32 v160, 0
    v_mov_b32 v161, 0
    v_mov_b32 v162, 0
    v_mov_b32 v163, 0
    v_mov_b32 v164, 0
    v_mov_b32 v165, 0
    v_mov_b32 v166, 0
    v_mov_b32 v167, 0
    s_waitcnt vmcnt(27)
    v_lshlrev_b32 v168, 16, v48
    v_and_b32 v169, 0xffff0000, v48
    v_lshlrev_b32 v170, 16, v49
    v_and_b32 v171, 0xffff0000, v49
    v_lshlrev_b32 v172, 16, v50
    v_and_b32 v173, 0xffff0000, v50
    v_lshlrev_b32 v174, 16, v51
    v_and_b32 v175, 0xffff0000, v51
    v_fmac_f32 v160, v16, v168
    v_fmac_f32 v161, v16, v169
    v_fmac_f32 v162, v16, v170
    v_fmac_f32 v163, v16, v171
    v_fmac_f32 v164, v16, v172
    v_fmac_f32 v165, v16, v173
    v_fmac_f32 v166, v16, v174
    v_fmac_f32 v167, v16, v175
    s_waitcnt vmcnt(26)
    v_lshlrev_b32 v168, 16, v52
    v_and_b32 v169, 0xffff0000, v52
    v_lshlrev_b32 v170, 16, v53
    v_and_b32 v171, 0xffff0000, v53
    v_lshlrev_b32 v172, 16, v54
    v_and_b32 v173, 0xffff0000, v54
    v_lshlrev_b32 v174, 16, v55
    v_and_b32 v175, 0xffff0000, v55
    v_fmac_f32 v160, v17, v168
    v_fmac_f32 v161, v17, v169
    v_fmac_f32 v162, v17, v170
    v_fmac_f32 v163, v17, v171
    v_fmac_f32 v164, v17, v172
    v_fmac_f32 v165, v17, v173
    v_fmac_f32 v166, v17, v174
    v_fmac_f32 v167, v17, v175
    s_waitcnt vmcnt(25)
    v_lshlrev_b32 v168, 16, v56
    v_and_b32 v169, 0xffff0000, v56
    v_lshlrev_b32 v170, 16, v57
    v_and_b32 v171, 0xffff0000, v57
    v_lshlrev_b32 v172, 16, v58
    v_and_b32 v173, 0xffff0000, v58
    v_lshlrev_b32 v174, 16, v59
    v_and_b32 v175, 0xffff0000, v59
    v_fmac_f32 v160, v18, v168
    v_fmac_f32 v161, v18, v169
    v_fmac_f32 v162, v18, v170
    v_fmac_f32 v163, v18, v171
    v_fmac_f32 v164, v18, v172
    v_fmac_f32 v165, v18, v173
    v_fmac_f32 v166, v18, v174
    v_fmac_f32 v167, v18, v175
    s_waitcnt vmcnt(24)
    v_lshlrev_b32 v168, 16, v60
    v_and_b32 v169, 0xffff0000, v60
    v_lshlrev_b32 v170, 16, v61
    v_and_b32 v171, 0xffff0000, v61
    v_lshlrev_b32 v172, 16, v62
    v_and_b32 v173, 0xffff0000, v62
    v_lshlrev_b32 v174, 16, v63
    v_and_b32 v175, 0xffff0000, v63
    v_fmac_f32 v160, v19, v168
    v_fmac_f32 v161, v19, v169
    v_fmac_f32 v162, v19, v170
    v_fmac_f32 v163, v19, v171
    v_fmac_f32 v164, v19, v172
    v_fmac_f32 v165, v19, v173
    v_fmac_f32 v166, v19, v174
    v_fmac_f32 v167, v19, v175
    s_waitcnt vmcnt(23)
    v_lshlrev_b32 v168, 16, v64
    v_and_b32 v169, 0xffff0000, v64
    v_lshlrev_b32 v170, 16, v65
    v_and_b32 v171, 0xffff0000, v65
    v_lshlrev_b32 v172, 16, v66
    v_and_b32 v173, 0xffff0000, v66
    v_lshlrev_b32 v174, 16, v67
    v_and_b32 v175, 0xffff0000, v67
    v_fmac_f32 v160, v20, v168
    v_fmac_f32 v161, v20, v169
    v_fmac_f32 v162, v20, v170
    v_fmac_f32 v163, v20, v171
    v_fmac_f32 v164, v20, v172
    v_fmac_f32 v165, v20, v173
    v_fmac_f32 v166, v20, v174
    v_fmac_f32 v167, v20, v175
    s_waitcnt vmcnt(22)
    v_lshlrev_b32 v168, 16, v68
    v_and_b32 v169, 0xffff0000, v68
    v_lshlrev_b32 v170, 16, v69
    v_and_b32 v171, 0xffff0000, v69
    v_lshlrev_b32 v172, 16, v70
    v_and_b32 v173, 0xffff0000, v70
    v_lshlrev_b32 v174, 16, v71
    v_and_b32 v175, 0xffff0000, v71
    v_fmac_f32 v160, v21, v168
    v_fmac_f32 v161, v21, v169
    v_fmac_f32 v162, v21, v170
    v_fmac_f32 v163, v21, v171
    v_fmac_f32 v164, v21, v172
    v_fmac_f32 v165, v21, v173
    v_fmac_f32 v166, v21, v174
    v_fmac_f32 v167, v21, v175
    s_waitcnt vmcnt(21)
    v_lshlrev_b32 v168, 16, v72
    v_and_b32 v169, 0xffff0000, v72
    v_lshlrev_b32 v170, 16, v73
    v_and_b32 v171, 0xffff0000, v73
    v_lshlrev_b32 v172, 16, v74
    v_and_b32 v173, 0xffff0000, v74
    v_lshlrev_b32 v174, 16, v75
    v_and_b32 v175, 0xffff0000, v75
    v_fmac_f32 v160, v22, v168
    v_fmac_f32 v161, v22, v169
    v_fmac_f32 v162, v22, v170
    v_fmac_f32 v163, v22, v171
    v_fmac_f32 v164, v22, v172
    v_fmac_f32 v165, v22, v173
    v_fmac_f32 v166, v22, v174
    v_fmac_f32 v167, v22, v175
    s_waitcnt vmcnt(20)
    v_lshlrev_b32 v168, 16, v76
    v_and_b32 v169, 0xffff0000, v76
    v_lshlrev_b32 v170, 16, v77
    v_and_b32 v171, 0xffff0000, v77
    v_lshlrev_b32 v172, 16, v78
    v_and_b32 v173, 0xffff0000, v78
    v_lshlrev_b32 v174, 16, v79
    v_and_b32 v175, 0xffff0000, v79
    v_fmac_f32 v160, v23, v168
    v_fmac_f32 v161, v23, v169
    v_fmac_f32 v162, v23, v170
    v_fmac_f32 v163, v23, v171
    v_fmac_f32 v164, v23, v172
    v_fmac_f32 v165, v23, v173
    v_fmac_f32 v166, v23, v174
    v_fmac_f32 v167, v23, v175
    s_waitcnt vmcnt(19)
    v_lshlrev_b32 v168, 16, v80
    v_and_b32 v169, 0xffff0000, v80
    v_lshlrev_b32 v170, 16, v81
    v_and_b32 v171, 0xffff0000, v81
    v_lshlrev_b32 v172, 16, v82
    v_and_b32 v173, 0xffff0000, v82
    v_lshlrev_b32 v174, 16, v83
    v_and_b32 v175, 0xffff0000, v83
    v_fmac_f32 v160, v24, v168
    v_fmac_f32 v161, v24, v169
    v_fmac_f32 v162, v24, v170
    v_fmac_f32 v163, v24, v171
    v_fmac_f32 v164, v24, v172
    v_fmac_f32 v165, v24, v173
    v_fmac_f32 v166, v24, v174
    v_fmac_f32 v167, v24, v175
    s_waitcnt vmcnt(18)
    v_lshlrev_b32 v168, 16, v84
    v_and_b32 v169, 0xffff0000, v84
    v_lshlrev_b32 v170, 16, v85
    v_and_b32 v171, 0xffff0000, v85
    v_lshlrev_b32 v172, 16, v86
    v_and_b32 v173, 0xffff0000, v86
    v_lshlrev_b32 v174, 16, v87
    v_and_b32 v175, 0xffff0000, v87
    v_fmac_f32 v160, v25, v168
    v_fmac_f32 v161, v25, v169
    v_fmac_f32 v162, v25, v170
    v_fmac_f32 v163, v25, v171
    v_fmac_f32 v164, v25, v172
    v_fmac_f32 v165, v25, v173
    v_fmac_f32 v166, v25, v174
    v_fmac_f32 v167, v25, v175
    s_waitcnt vmcnt(17)
    v_lshlrev_b32 v168, 16, v88
    v_and_b32 v169, 0xffff0000, v88
    v_lshlrev_b32 v170, 16, v89
    v_and_b32 v171, 0xffff0000, v89
    v_lshlrev_b32 v172, 16, v90
    v_and_b32 v173, 0xffff0000, v90
    v_lshlrev_b32 v174, 16, v91
    v_and_b32 v175, 0xffff0000, v91
    v_fmac_f32 v160, v26, v168
    v_fmac_f32 v161, v26, v169
    v_fmac_f32 v162, v26, v170
    v_fmac_f32 v163, v26, v171
    v_fmac_f32 v164, v26, v172
    v_fmac_f32 v165, v26, v173
    v_fmac_f32 v166, v26, v174
    v_fmac_f32 v167, v26, v175
    s_waitcnt vmcnt(16)
    v_lshlrev_b32 v168, 16, v92
    v_and_b32 v169, 0xffff0000, v92
    v_lshlrev_b32 v170, 16, v93
    v_and_b32 v171, 0xffff0000, v93
    v_lshlrev_b32 v172, 16, v94
    v_and_b32 v173, 0xffff0000, v94
    v_lshlrev_b32 v174, 16, v95
    v_and_b32 v175, 0xffff0000, v95
    v_fmac_f32 v160, v27, v168
    v_fmac_f32 v161, v27, v169
    v_fmac_f32 v162, v27, v170
    v_fmac_f32 v163, v27, v171
    v_fmac_f32 v164, v27, v172
    v_fmac_f32 v165, v27, v173
    v_fmac_f32 v166, v27, v174
    v_fmac_f32 v167, v27, v175
    s_waitcnt vmcnt(15)
    v_lshlrev_b32 v168, 16, v96
    v_and_b32 v169, 0xffff0000, v96
    v_lshlrev_b32 v170, 16, v97
    v_and_b32 v171, 0xffff0000, v97
    v_lshlrev_b32 v172, 16, v98
    v_and_b32 v173, 0xffff0000, v98
    v_lshlrev_b32 v174, 16, v99
    v_and_b32 v175, 0xffff0000, v99
    v_fmac_f32 v160, v28, v168
    v_fmac_f32 v161, v28, v169
    v_fmac_f32 v162, v28, v170
    v_fmac_f32 v163, v28, v171
    v_fmac_f32 v164, v28, v172
    v_fmac_f32 v165, v28, v173
    v_fmac_f32 v166, v28, v174
    v_fmac_f32 v167, v28, v175
    s_waitcnt vmcnt(14)
    v_lshlrev_b32 v168, 16, v100
    v_and_b32 v169, 0xffff0000, v100
    v_lshlrev_b32 v170, 16, v101
    v_and_b32 v171, 0xffff0000, v101
    v_lshlrev_b32 v172, 16, v102
    v_and_b32 v173, 0xffff0000, v102
    v_lshlrev_b32 v174, 16, v103
    v_and_b32 v175, 0xffff0000, v103
    v_fmac_f32 v160, v29, v168
    v_fmac_f32 v161, v29, v169
    v_fmac_f32 v162, v29, v170
    v_fmac_f32 v163, v29, v171
    v_fmac_f32 v164, v29, v172
    v_fmac_f32 v165, v29, v173
    v_fmac_f32 v166, v29, v174
    v_fmac_f32 v167, v29, v175
    s_waitcnt vmcnt(13)
    v_lshlrev_b32 v168, 16, v104
    v_and_b32 v169, 0xffff0000, v104
    v_lshlrev_b32 v170, 16, v105
    v_and_b32 v171, 0xffff0000, v105
    v_lshlrev_b32 v172, 16, v106
    v_and_b32 v173, 0xffff0000, v106
    v_lshlrev_b32 v174, 16, v107
    v_and_b32 v175, 0xffff0000, v107
    v_fmac_f32 v160, v30, v168
    v_fmac_f32 v161, v30, v169
    v_fmac_f32 v162, v30, v170
    v_fmac_f32 v163, v30, v171
    v_fmac_f32 v164, v30, v172
    v_fmac_f32 v165, v30, v173
    v_fmac_f32 v166, v30, v174
    v_fmac_f32 v167, v30, v175
    s_waitcnt vmcnt(12)
    v_lshlrev_b32 v168, 16, v108
    v_and_b32 v169, 0xffff0000, v108
    v_lshlrev_b32 v170, 16, v109
    v_and_b32 v171, 0xffff0000, v109
    v_lshlrev_b32 v172, 16, v110
    v_and_b32 v173, 0xffff0000, v110
    v_lshlrev_b32 v174, 16, v111
    v_and_b32 v175, 0xffff0000, v111
    v_fmac_f32 v160, v31, v168
    v_fmac_f32 v161, v31, v169
    v_fmac_f32 v162, v31, v170
    v_fmac_f32 v163, v31, v171
    v_fmac_f32 v164, v31, v172
    v_fmac_f32 v165, v31, v173
    v_fmac_f32 v166, v31, v174
    v_fmac_f32 v167, v31, v175
    s_waitcnt vmcnt(11)
    v_lshlrev_b32 v168, 16, v112
    v_and_b32 v169, 0xffff0000, v112
    v_lshlrev_b32 v170, 16, v113
    v_and_b32 v171, 0xffff0000, v113
    v_lshlrev_b32 v172, 16, v114
    v_and_b32 v173, 0xffff0000, v114
    v_lshlrev_b32 v174, 16, v115
    v_and_b32 v175, 0xffff0000, v115
    v_fmac_f32 v160, v32, v168
    v_fmac_f32 v161, v32, v169
    v_fmac_f32 v162, v32, v170
    v_fmac_f32 v163, v32, v171
    v_fmac_f32 v164, v32, v172
    v_fmac_f32 v165, v32, v173
    v_fmac_f32 v166, v32, v174
    v_fmac_f32 v167, v32, v175
    s_waitcnt vmcnt(10)
    v_lshlrev_b32 v168, 16, v116
    v_and_b32 v169, 0xffff0000, v116
    v_lshlrev_b32 v170, 16, v117
    v_and_b32 v171, 0xffff0000, v117
    v_lshlrev_b32 v172, 16, v118
    v_and_b32 v173, 0xffff0000, v118
    v_lshlrev_b32 v174, 16, v119
    v_and_b32 v175, 0xffff0000, v119
    v_fmac_f32 v160, v33, v168
    v_fmac_f32 v161, v33, v169
    v_fmac_f32 v162, v33, v170
    v_fmac_f32 v163, v33, v171
    v_fmac_f32 v164, v33, v172
    v_fmac_f32 v165, v33, v173
    v_fmac_f32 v166, v33, v174
    v_fmac_f32 v167, v33, v175
    s_waitcnt vmcnt(9)
    v_lshlrev_b32 v168, 16, v120
    v_and_b32 v169, 0xffff0000, v120
    v_lshlrev_b32 v170, 16, v121
    v_and_b32 v171, 0xffff0000, v121
    v_lshlrev_b32 v172, 16, v122
    v_and_b32 v173, 0xffff0000, v122
    v_lshlrev_b32 v174, 16, v123
    v_and_b32 v175, 0xffff0000, v123
    v_fmac_f32 v160, v34, v168
    v_fmac_f32 v161, v34, v169
    v_fmac_f32 v162, v34, v170
    v_fmac_f32 v163, v34, v171
    v_fmac_f32 v164, v34, v172
    v_fmac_f32 v165, v34, v173
    v_fmac_f32 v166, v34, v174
    v_fmac_f32 v167, v34, v175
    s_waitcnt vmcnt(8)
    v_lshlrev_b32 v168, 16, v124
    v_and_b32 v169, 0xffff0000, v124
    v_lshlrev_b32 v170, 16, v125
    v_and_b32 v171, 0xffff0000, v125
    v_lshlrev_b32 v172, 16, v126
    v_and_b32 v173, 0xffff0000, v126
    v_lshlrev_b32 v174, 16, v127
    v_and_b32 v175, 0xffff0000, v127
    v_fmac_f32 v160, v35, v168
    v_fmac_f32 v161, v35, v169
    v_fmac_f32 v162, v35, v170
    v_fmac_f32 v163, v35, v171
    v_fmac_f32 v164, v35, v172
    v_fmac_f32 v165, v35, v173
    v_fmac_f32 v166, v35, v174
    v_fmac_f32 v167, v35, v175
    s_waitcnt vmcnt(7)
    v_lshlrev_b32 v168, 16, v128
    v_and_b32 v169, 0xffff0000, v128
    v_lshlrev_b32 v170, 16, v129
    v_and_b32 v171, 0xffff0000, v129
    v_lshlrev_b32 v172, 16, v130
    v_and_b32 v173, 0xffff0000, v130
    v_lshlrev_b32 v174, 16, v131
    v_and_b32 v175, 0xffff0000, v131
    v_fmac_f32 v160, v36, v168
    v_fmac_f32 v161, v36, v169
    v_fmac_f32 v162, v36, v170
    v_fmac_f32 v163, v36, v171
    v_fmac_f32 v164, v36, v172
    v_fmac_f32 v165, v36, v173
    v_fmac_f32 v166, v36, v174
    v_fmac_f32 v167, v36, v175
    s_waitcnt vmcnt(6)
    v_lshlrev_b32 v168, 16, v132
    v_and_b32 v169, 0xffff0000, v132
    v_lshlrev_b32 v170, 16, v133
    v_and_b32 v171, 0xffff0000, v133
    v_lshlrev_b32 v172, 16, v134
    v_and_b32 v173, 0xffff0000, v134
    v_lshlrev_b32 v174, 16, v135
    v_and_b32 v175, 0xffff0000, v135
    v_fmac_f32 v160, v37, v168
    v_fmac_f32 v161, v37, v169
    v_fmac_f32 v162, v37, v170
    v_fmac_f32 v163, v37, v171
    v_fmac_f32 v164, v37, v172
    v_fmac_f32 v165, v37, v173
    v_fmac_f32 v166, v37, v174
    v_fmac_f32 v167, v37, v175
    s_waitcnt vmcnt(5)
    v_lshlrev_b32 v168, 16, v136
    v_and_b32 v169, 0xffff0000, v136
    v_lshlrev_b32 v170, 16, v137
    v_and_b32 v171, 0xffff0000, v137
    v_lshlrev_b32 v172, 16, v138
    v_and_b32 v173, 0xffff0000, v138
    v_lshlrev_b32 v174, 16, v139
    v_and_b32 v175, 0xffff0000, v139
    v_fmac_f32 v160, v38, v168
    v_fmac_f32 v161, v38, v169
    v_fmac_f32 v162, v38, v170
    v_fmac_f32 v163, v38, v171
    v_fmac_f32 v164, v38, v172
    v_fmac_f32 v165, v38, v173
    v_fmac_f32 v166, v38, v174
    v_fmac_f32 v167, v38, v175
    s_waitcnt vmcnt(4)
    v_lshlrev_b32 v168, 16, v140
    v_and_b32 v169, 0xffff0000, v140
    v_lshlrev_b32 v170, 16, v141
    v_and_b32 v171, 0xffff0000, v141
    v_lshlrev_b32 v172, 16, v142
    v_and_b32 v173, 0xffff0000, v142
    v_lshlrev_b32 v174, 16, v143
    v_and_b32 v175, 0xffff0000, v143
    v_fmac_f32 v160, v39, v168
    v_fmac_f32 v161, v39, v169
    v_fmac_f32 v162, v39, v170
    v_fmac_f32 v163, v39, v171
    v_fmac_f32 v164, v39, v172
    v_fmac_f32 v165, v39, v173
    v_fmac_f32 v166, v39, v174
    v_fmac_f32 v167, v39, v175
    s_waitcnt vmcnt(3)
    v_lshlrev_b32 v168, 16, v144
    v_and_b32 v169, 0xffff0000, v144
    v_lshlrev_b32 v170, 16, v145
    v_and_b32 v171, 0xffff0000, v145
    v_lshlrev_b32 v172, 16, v146
    v_and_b32 v173, 0xffff0000, v146
    v_lshlrev_b32 v174, 16, v147
    v_and_b32 v175, 0xffff0000, v147
    v_fmac_f32 v160, v40, v168
    v_fmac_f32 v161, v40, v169
    v_fmac_f32 v162, v40, v170
    v_fmac_f32 v163, v40, v171
    v_fmac_f32 v164, v40, v172
    v_fmac_f32 v165, v40, v173
    v_fmac_f32 v166, v40, v174
    v_fmac_f32 v167, v40, v175
    s_waitcnt vmcnt(2)
    v_lshlrev_b32 v168, 16, v148
    v_and_b32 v169, 0xffff0000, v148
    v_lshlrev_b32 v170, 16, v149
    v_and_b32 v171, 0xffff0000, v149
    v_lshlrev_b32 v172, 16, v150
    v_and_b32 v173, 0xffff0000, v150
    v_lshlrev_b32 v174, 16, v151
    v_and_b32 v175, 0xffff0000, v151
    v_fmac_f32 v160, v41, v168
    v_fmac_f32 v161, v41, v169
    v_fmac_f32 v162, v41, v170
    v_fmac_f32 v163, v41, v171
    v_fmac_f32 v164, v41, v172
    v_fmac_f32 v165, v41, v173
    v_fmac_f32 v166, v41, v174
    v_fmac_f32 v167, v41, v175
    s_waitcnt vmcnt(1)
    v_lshlrev_b32 v168, 16, v152
    v_and_b32 v169, 0xffff0000, v152
    v_lshlrev_b32 v170, 16, v153
    v_and_b32 v171, 0xffff0000, v153
    v_lshlrev_b32 v172, 16, v154
    v_and_b32 v173, 0xffff0000, v154
    v_lshlrev_b32 v174, 16, v155
    v_and_b32 v175, 0xffff0000, v155
    v_fmac_f32 v160, v42, v168
    v_fmac_f32 v161, v42, v169
    v_fmac_f32 v162, v42, v170
    v_fmac_f32 v163, v42, v171
    v_fmac_f32 v164, v42, v172
    v_fmac_f32 v165, v42, v173
    v_fmac_f32 v166, v42, v174
    v_fmac_f32 v167, v42, v175
    s_waitcnt vmcnt(0)
    v_lshlrev_b32 v168, 16, v156
    v_and_b32 v169, 0xffff0000, v156
    v_lshlrev_b32 v170, 16, v157
    v_and_b32 v171, 0xffff0000, v157
    v_lshlrev_b32 v172, 16, v158
    v_and_b32 v173, 0xffff0000, v158
    v_lshlrev_b32 v174, 16, v159
    v_and_b32 v175, 0xffff0000, v159
    v_fmac_f32 v160, v43, v168
    v_fmac_f32 v161, v43, v169
    v_fmac_f32 v162, v43, v170
    v_fmac_f32 v163, v43, v171
    v_fmac_f32 v164, v43, v172
    v_fmac_f32 v165, v43, v173
    v_fmac_f32 v166, v43, v174
    v_fmac_f32 v167, v43, v175
    v_lshlrev_b32 v11, 5, v0
    ds_write_b128 v11, v[160:163]
    ds_write_b128 v11, v[164:167] offset:16
    s_waitcnt lgkmcnt(0)
    s_barrier
    s_cmp_ge_u32 s32, 2
    s_cbranch_scc1 Lgv_36
    v_lshlrev_b32 v11, 2, v0
    ds_read_b32 v16, v11 offset:0
    ds_read_b32 v17, v11 offset:512
    ds_read_b32 v18, v11 offset:1024
    ds_read_b32 v19, v11 offset:1536
    ds_read_b32 v20, v11 offset:2048
    ds_read_b32 v21, v11 offset:2560
    ds_read_b32 v22, v11 offset:3072
    ds_read_b32 v23, v11 offset:3584
    ds_read_b32 v24, v11 offset:4096
    ds_read_b32 v25, v11 offset:4608
    ds_read_b32 v26, v11 offset:5120
    ds_read_b32 v27, v11 offset:5632
    ds_read_b32 v28, v11 offset:6144
    ds_read_b32 v29, v11 offset:6656
    ds_read_b32 v30, v11 offset:7168
    ds_read_b32 v31, v11 offset:7680
    s_waitcnt lgkmcnt(0)
    v_add_f32 v16, v16, v17
    v_add_f32 v18, v18, v19
    v_add_f32 v20, v20, v21
    v_add_f32 v22, v22, v23
    v_add_f32 v24, v24, v25
    v_add_f32 v26, v26, v27
    v_add_f32 v28, v28, v29
    v_add_f32 v30, v30, v31
    v_add_f32 v16, v16, v18
    v_add_f32 v20, v20, v22
    v_add_f32 v24, v24, v26
    v_add_f32 v28, v28, v30
    v_add_f32 v16, v16, v20
    v_add_f32 v24, v24, v28
    v_add_f32 v16, v16, v24
    v_cvt_pk_bf16_f32 v16, v16, v16
    v_lshlrev_b32 v17, 16, v16
    v_add_f32 v17, 1.0, v17
    v_cvt_pk_bf16_f32 v17, v17, v17
    s_lshl_b32 s93, s36, 7
    v_add_u32 v18, s93, v0
    v_lshrrev_b32 v19, 6, v18
    v_mul_u32_u24 v19, 9363, v19
    v_lshrrev_b32 v19, 16, v19
    v_cmp_eq_u32 vcc, 1, v19
    v_cmp_eq_u32 s[94:95], 4, v19
    s_or_b64 vcc, vcc, s[94:95]
    s_nop 1
    v_cndmask_b32 v16, v16, v17, vcc
    v_lshlrev_b32 v18, 1, v18
    buffer_store_short v16, v18, s[52:55], 0 offen sc1
Lgv_36:
    s_cmp_lg_u32 s32, 0
    s_cbranch_scc1 Lwg_37
    s_mov_b32 s44, s28
    s_mov_b32 s45, s29
    s_mov_b32 s46, 256
    s_mov_b32 s47, 0x00020000
    v_and_b32 v8, 0x01000000, v4
    v_add_u32 v240, 1, v240
    v_add_u32 v241, 1, v241
    v_add_u32 v242, 1, v242
    v_add_u32 v243, 1, v243
    s_mov_b32 s3, 0
Lgl_38:
    buffer_load_dwordx4 v[248:251], v246, s[40:43], 0 offen sc1
    s_waitcnt vmcnt(0)
    v_xor_b32 v248, v248, v240
    v_xor_b32 v249, v249, v241
    v_xor_b32 v250, v250, v242
    v_xor_b32 v251, v251, v243
    v_bfi_b32 v251, v4, 0, v251
    v_or_b32 v248, v248, v249
    v_or3_b32 v248, v248, v250, v251
    v_cmp_ne_u32 vcc, 0, v248
    s_cbranch_vccz Lgd_39
    buffer_load_dword v1, v2, s[44:47], 0 offen sc1
    s_waitcnt vmcnt(0)
    v_or_b32 v1, v1, v8
    v_cmp_ne_u32 vcc, 0x01010101, v1
    s_cbranch_vccz Lgd_39
    s_sleep 8
    s_add_u32 s3, s3, 1
    s_cmp_lt_u32 s3, 200000
    s_cbranch_scc1 Lgl_38
Lgd_39:
Lwg_37:
    s_waitcnt vmcnt(0)
    s_barrier
    s_cmp_lg_u32 s32, 0
    s_cbranch_scc1 Lmr_40
    s_mov_b64 exec, 0xffff
    v_mov_b32 v1, 1
    s_lshl_b32 s3, s36, 2
    s_add_u32 s3, s3, 20480
    v_lshl_add_u32 v8, v2, 5, s3
    buffer_store_dword v1, v8, s[40:43], 0 offen sc1
    s_mov_b64 exec, -1
Lmr_40:
    s_mov_b32 s44, s20
    s_mov_b32 s45, s21
    s_mov_b32 s46, 1605632
    s_mov_b32 s47, 0x00020000
    s_add_u32 s48, s30, 20971520
    s_addc_u32 s49, s31, 0
    s_mov_b32 s50, 1605632
    s_mov_b32 s51, 0x00020000
    v_lshrrev_b32 v8, 4, v2
    v_mul_u32_u24 v9, 896, v8
    v_and_b32 v10, 48, v5
    v_add_u32 v9, v9, v10
    v_lshrrev_b32 v10, 7, v2
    v_and_b32 v8, 3, v8
    v_lshl_add_u32 v10, v10, 2, v8
    v_lshlrev_b32 v10, 6, v10
    v_bfe_u32 v8, v2, 6, 1
    v_lshl_add_u32 v10, v8, 5, v10
    v_and_b32 v8, 12, v2
    v_lshl_add_u32 v10, v8, 1, v10
    s_mul_i32 s92, s32, 13312
    v_add_u32 v10, s92, v10
    s_mul_i32 s93, s36, 49
    s_add_u32 s93, s93, s32
    s_add_u32 s94, s93, 0
    s_lshr_b32 s95, s94, 1
    s_mul_hi_u32 s96, s95, 38347923
    s_mul_i32 s97, s96, 112
    s_sub_u32 s95, s95, s97
    s_mul_i32 s95, s95, 14336
    s_lshl_b32 s96, s96, 7
    s_add_u32 s95, s95, s96
    s_and_b32 s94, s94, 1
    s_lshl_b32 s94, s94, 6
    s_add_u32 m0, s92, 0
    s_add_u32 s95, s95, s94
    buffer_load_dwordx4 v9, s[44:47], s95 offen lds
    s_add_u32 s94, s93, 4
    s_lshr_b32 s95, s94, 1
    s_mul_hi_u32 s96, s95, 38347923
    s_mul_i32 s97, s96, 112
    s_sub_u32 s95, s95, s97
    s_mul_i32 s95, s95, 14336
    s_lshl_b32 s96, s96, 7
    s_add_u32 s95, s95, s96
    s_and_b32 s94, s94, 1
    s_lshl_b32 s94, s94, 6
    s_add_u32 m0, s92, 1024
    s_add_u32 s95, s95, s94
    buffer_load_dwordx4 v9, s[44:47], s95 offen lds
    s_add_u32 s94, s93, 8
    s_lshr_b32 s95, s94, 1
    s_mul_hi_u32 s96, s95, 38347923
    s_mul_i32 s97, s96, 112
    s_sub_u32 s95, s95, s97
    s_mul_i32 s95, s95, 14336
    s_lshl_b32 s96, s96, 7
    s_add_u32 s95, s95, s96
    s_and_b32 s94, s94, 1
    s_lshl_b32 s94, s94, 6
    s_add_u32 m0, s92, 2048
    s_add_u32 s95, s95, s94
    buffer_load_dwordx4 v9, s[44:47], s95 offen lds
    s_add_u32 s94, s93, 12
    s_lshr_b32 s95, s94, 1
    s_mul_hi_u32 s96, s95, 38347923
    s_mul_i32 s97, s96, 112
    s_sub_u32 s95, s95, s97
    s_mul_i32 s95, s95, 14336
    s_lshl_b32 s96, s96, 7
    s_add_u32 s95, s95, s96
    s_and_b32 s94, s94, 1
    s_lshl_b32 s94, s94, 6
    s_add_u32 m0, s92, 3072
    s_add_u32 s95, s95, s94
    buffer_load_dwordx4 v9, s[44:47], s95 offen lds
    s_add_u32 s94, s93, 16
    s_lshr_b32 s95, s94, 1
    s_mul_hi_u32 s96, s95, 38347923
    s_mul_i32 s97, s96, 112
    s_sub_u32 s95, s95, s97
    s_mul_i32 s95, s95, 14336
    s_lshl_b32 s96, s96, 7
    s_add_u32 s95, s95, s96
    s_and_b32 s94, s94, 1
    s_lshl_b32 s94, s94, 6
    s_add_u32 m0, s92, 4096
    s_add_u32 s95, s95, s94
    buffer_load_dwordx4 v9, s[44:47], s95 offen lds
    s_add_u32 s94, s93, 20
    s_lshr_b32 s95, s94, 1
    s_mul_hi_u32 s96, s95, 38347923
    s_mul_i32 s97, s96, 112
    s_sub_u32 s95, s95, s97
    s_mul_i32 s95, s95, 14336
    s_lshl_b32 s96, s96, 7
    s_add_u32 s95, s95, s96
    s_and_b32 s94, s94, 1
    s_lshl_b32 s94, s94, 6
    s_add_u32 m0, s92, 5120
    s_add_u32 s95, s95, s94
    buffer_load_dwordx4 v9, s[44:47], s95 offen lds
    s_add_u32 s94, s93, 24
    s_lshr_b32 s95, s94, 1
    s_mul_hi_u32 s96, s95, 38347923
    s_mul_i32 s97, s96, 112
    s_sub_u32 s95, s95, s97
    s_mul_i32 s95, s95, 14336
    s_lshl_b32 s96, s96, 7
    s_add_u32 s95, s95, s96
    s_and_b32 s94, s94, 1
    s_lshl_b32 s94, s94, 6
    s_add_u32 m0, s92, 6144
    s_add_u32 s95, s95, s94
    buffer_load_dwordx4 v9, s[44:47], s95 offen lds
    s_add_u32 s94, s93, 28
    s_lshr_b32 s95, s94, 1
    s_mul_hi_u32 s96, s95, 38347923
    s_mul_i32 s97, s96, 112
    s_sub_u32 s95, s95, s97
    s_mul_i32 s95, s95, 14336
    s_lshl_b32 s96, s96, 7
    s_add_u32 s95, s95, s96
    s_and_b32 s94, s94, 1
    s_lshl_b32 s94, s94, 6
    s_add_u32 m0, s92, 7168
    s_add_u32 s95, s95, s94
    buffer_load_dwordx4 v9, s[44:47], s95 offen lds
    s_add_u32 s94, s93, 32
    s_lshr_b32 s95, s94, 1
    s_mul_hi_u32 s96, s95, 38347923
    s_mul_i32 s97, s96, 112
    s_sub_u32 s95, s95, s97
    s_mul_i32 s95, s95, 14336
    s_lshl_b32 s96, s96, 7
    s_add_u32 s95, s95, s96
    s_and_b32 s94, s94, 1
    s_lshl_b32 s94, s94, 6
    s_add_u32 m0, s92, 8192
    s_add_u32 s95, s95, s94
    buffer_load_dwordx4 v9, s[44:47], s95 offen lds
    s_add_u32 s94, s93, 36
    s_lshr_b32 s95, s94, 1
    s_mul_hi_u32 s96, s95, 38347923
    s_mul_i32 s97, s96, 112
    s_sub_u32 s95, s95, s97
    s_mul_i32 s95, s95, 14336
    s_lshl_b32 s96, s96, 7
    s_add_u32 s95, s95, s96
    s_and_b32 s94, s94, 1
    s_lshl_b32 s94, s94, 6
    s_add_u32 m0, s92, 9216
    s_add_u32 s95, s95, s94
    buffer_load_dwordx4 v9, s[44:47], s95 offen lds
    s_add_u32 s94, s93, 40
    s_lshr_b32 s95, s94, 1
    s_mul_hi_u32 s96, s95, 38347923
    s_mul_i32 s97, s96, 112
    s_sub_u32 s95, s95, s97
    s_mul_i32 s95, s95, 14336
    s_lshl_b32 s96, s96, 7
    s_add_u32 s95, s95, s96
    s_and_b32 s94, s94, 1
    s_lshl_b32 s94, s94, 6
    s_add_u32 m0, s92, 10240
    s_add_u32 s95, s95, s94
    buffer_load_dwordx4 v9, s[44:47], s95 offen lds
    s_add_u32 s94, s93, 44
    s_lshr_b32 s95, s94, 1
    s_mul_hi_u32 s96, s95, 38347923
    s_mul_i32 s97, s96, 112
    s_sub_u32 s95, s95, s97
    s_mul_i32 s95, s95, 14336
    s_lshl_b32 s96, s96, 7
    s_add_u32 s95, s95, s96
    s_and_b32 s94, s94, 1
    s_lshl_b32 s94, s94, 6
    s_add_u32 m0, s92, 11264
    s_add_u32 s95, s95, s94
    buffer_load_dwordx4 v9, s[44:47], s95 offen lds
    s_cmp_lg_u32 s32, 0
    s_cbranch_scc1 Lrw_41
    s_add_u32 s94, s93, 48
    s_lshr_b32 s95, s94, 1
    s_mul_hi_u32 s96, s95, 38347923
    s_mul_i32 s97, s96, 112
    s_sub_u32 s95, s95, s97
    s_mul_i32 s95, s95, 14336
    s_lshl_b32 s96, s96, 7
    s_add_u32 s95, s95, s96
    s_and_b32 s94, s94, 1
    s_lshl_b32 s94, s94, 6
    s_add_u32 m0, s92, 12288
    s_add_u32 s95, s95, s94
    buffer_load_dwordx4 v9, s[44:47], s95 offen lds
Lrw_41:
    s_waitcnt vmcnt(0)
    ds_read_b64_tr_b16 v[16:17], v10 offset:0
    ds_read_b64_tr_b16 v[18:19], v10 offset:512
    ds_read_b64_tr_b16 v[20:21], v10 offset:1024
    ds_read_b64_tr_b16 v[22:23], v10 offset:1536
    ds_read_b64_tr_b16 v[24:25], v10 offset:2048
    ds_read_b64_tr_b16 v[26:27], v10 offset:2560
    ds_read_b64_tr_b16 v[28:29], v10 offset:3072
    ds_read_b64_tr_b16 v[30:31], v10 offset:3584
    ds_read_b64_tr_b16 v[32:33], v10 offset:4096
    ds_read_b64_tr_b16 v[34:35], v10 offset:4608
    ds_read_b64_tr_b16 v[36:37], v10 offset:5120
    ds_read_b64_tr_b16 v[38:39], v10 offset:5632
    ds_read_b64_tr_b16 v[40:41], v10 offset:6144
    ds_read_b64_tr_b16 v[42:43], v10 offset:6656
    ds_read_b64_tr_b16 v[44:45], v10 offset:7168
    ds_read_b64_tr_b16 v[46:47], v10 offset:7680
    ds_read_b64_tr_b16 v[48:49], v10 offset:8192
    ds_read_b64_tr_b16 v[50:51], v10 offset:8704
    ds_read_b64_tr_b16 v[52:53], v10 offset:9216
    ds_read_b64_tr_b16 v[54:55], v10 offset:9728
    ds_read_b64_tr_b16 v[56:57], v10 offset:10240
    ds_read_b64_tr_b16 v[58:59], v10 offset:10752
    ds_read_b64_tr_b16 v[60:61], v10 offset:11264
    ds_read_b64_tr_b16 v[62:63], v10 offset:11776
    ds_read_b64_tr_b16 v[64:65], v10 offset:12288
    ds_read_b64_tr_b16 v[66:67], v10 offset:12800
    s_lshl_b32 s93, s93, 10
    s_waitcnt lgkmcnt(0)
    s_add_u32 s94, s93, 0
    buffer_store_dwordx4 v[16:19], v5, s[48:51], s94 offen sc1
    s_add_u32 s94, s93, 4096
    buffer_store_dwordx4 v[20:23], v5, s[48:51], s94 offen sc1
    s_add_u32 s94, s93, 8192
    buffer_store_dwordx4 v[24:27], v5, s[48:51], s94 offen sc1
    s_add_u32 s94, s93, 12288
    buffer_store_dwordx4 v[28:31], v5, s[48:51], s94 offen sc1
    s_add_u32 s94, s93, 16384
    buffer_store_dwordx4 v[32:35], v5, s[48:51], s94 offen sc1
    s_add_u32 s94, s93, 20480
    buffer_store_dwordx4 v[36:39], v5, s[48:51], s94 offen sc1
    s_add_u32 s94, s93, 24576
    buffer_store_dwordx4 v[40:43], v5, s[48:51], s94 offen sc1
    s_add_u32 s94, s93, 28672
    buffer_store_dwordx4 v[44:47], v5, s[48:51], s94 offen sc1
    s_add_u32 s94, s93, 32768
    buffer_store_dwordx4 v[48:51], v5, s[48:51], s94 offen sc1
    s_add_u32 s94, s93, 36864
    buffer_store_dwordx4 v[52:55], v5, s[48:51], s94 offen sc1
    s_add_u32 s94, s93, 40960
    buffer_store_dwordx4 v[56:59], v5, s[48:51], s94 offen sc1
    s_add_u32 s94, s93, 45056
    buffer_store_dwordx4 v[60:63], v5, s[48:51], s94 offen sc1
    s_cmp_lg_u32 s32, 0
    s_cbranch_scc1 Lrw_42
    s_add_u32 s94, s93, 49152
    buffer_store_dwordx4 v[64:67], v5, s[48:51], s94 offen sc1
Lrw_42:
    s_waitcnt vmcnt(0)
    s_barrier
    s_branch Lej_43
Lng_35:
    s_mov_b32 s44, s20
    s_mov_b32 s45, s21
    s_mov_b32 s46, 1605632
    s_mov_b32 s47, 0x00020000
    s_add_u32 s48, s30, 20971520
    s_addc_u32 s49, s31, 0
    s_mov_b32 s50, 1605632
    s_mov_b32 s51, 0x00020000
    v_lshrrev_b32 v8, 4, v2
    v_mul_u32_u24 v9, 896, v8
    v_and_b32 v10, 48, v5
    v_add_u32 v9, v9, v10
    v_lshrrev_b32 v10, 7, v2
    v_and_b32 v8, 3, v8
    v_lshl_add_u32 v10, v10, 2, v8
    v_lshlrev_b32 v10, 6, v10
    v_bfe_u32 v8, v2, 6, 1
    v_lshl_add_u32 v10, v8, 5, v10
    v_and_b32 v8, 12, v2
    v_lshl_add_u32 v10, v8, 1, v10
    s_mul_i32 s92, s32, 13312
    v_add_u32 v10, s92, v10
    s_mul_i32 s93, s36, 49
    s_add_u32 s93, s93, s32
    s_add_u32 s94, s93, 0
    s_lshr_b32 s95, s94, 1
    s_mul_hi_u32 s96, s95, 38347923
    s_mul_i32 s97, s96, 112
    s_sub_u32 s95, s95, s97
    s_mul_i32 s95, s95, 14336
    s_lshl_b32 s96, s96, 7
    s_add_u32 s95, s95, s96
    s_and_b32 s94, s94, 1
    s_lshl_b32 s94, s94, 6
    s_add_u32 m0, s92, 0
    s_add_u32 s95, s95, s94
    buffer_load_dwordx4 v9, s[44:47], s95 offen lds
    s_add_u32 s94, s93, 4
    s_lshr_b32 s95, s94, 1
    s_mul_hi_u32 s96, s95, 38347923
    s_mul_i32 s97, s96, 112
    s_sub_u32 s95, s95, s97
    s_mul_i32 s95, s95, 14336
    s_lshl_b32 s96, s96, 7
    s_add_u32 s95, s95, s96
    s_and_b32 s94, s94, 1
    s_lshl_b32 s94, s94, 6
    s_add_u32 m0, s92, 1024
    s_add_u32 s95, s95, s94
    buffer_load_dwordx4 v9, s[44:47], s95 offen lds
    s_add_u32 s94, s93, 8
    s_lshr_b32 s95, s94, 1
    s_mul_hi_u32 s96, s95, 38347923
    s_mul_i32 s97, s96, 112
    s_sub_u32 s95, s95, s97
    s_mul_i32 s95, s95, 14336
    s_lshl_b32 s96, s96, 7
    s_add_u32 s95, s95, s96
    s_and_b32 s94, s94, 1
    s_lshl_b32 s94, s94, 6
    s_add_u32 m0, s92, 2048
    s_add_u32 s95, s95, s94
    buffer_load_dwordx4 v9, s[44:47], s95 offen lds
    s_add_u32 s94, s93, 12
    s_lshr_b32 s95, s94, 1
    s_mul_hi_u32 s96, s95, 38347923
    s_mul_i32 s97, s96, 112
    s_sub_u32 s95, s95, s97
    s_mul_i32 s95, s95, 14336
    s_lshl_b32 s96, s96, 7
    s_add_u32 s95, s95, s96
    s_and_b32 s94, s94, 1
    s_lshl_b32 s94, s94, 6
    s_add_u32 m0, s92, 3072
    s_add_u32 s95, s95, s94
    buffer_load_dwordx4 v9, s[44:47], s95 offen lds
    s_add_u32 s94, s93, 16
    s_lshr_b32 s95, s94, 1
    s_mul_hi_u32 s96, s95, 38347923
    s_mul_i32 s97, s96, 112
    s_sub_u32 s95, s95, s97
    s_mul_i32 s95, s95, 14336
    s_lshl_b32 s96, s96, 7
    s_add_u32 s95, s95, s96
    s_and_b32 s94, s94, 1
    s_lshl_b32 s94, s94, 6
    s_add_u32 m0, s92, 4096
    s_add_u32 s95, s95, s94
    buffer_load_dwordx4 v9, s[44:47], s95 offen lds
    s_add_u32 s94, s93, 20
    s_lshr_b32 s95, s94, 1
    s_mul_hi_u32 s96, s95, 38347923
    s_mul_i32 s97, s96, 112
    s_sub_u32 s95, s95, s97
    s_mul_i32 s95, s95, 14336
    s_lshl_b32 s96, s96, 7
    s_add_u32 s95, s95, s96
    s_and_b32 s94, s94, 1
    s_lshl_b32 s94, s94, 6
    s_add_u32 m0, s92, 5120
    s_add_u32 s95, s95, s94
    buffer_load_dwordx4 v9, s[44:47], s95 offen lds
    s_add_u32 s94, s93, 24
    s_lshr_b32 s95, s94, 1
    s_mul_hi_u32 s96, s95, 38347923
    s_mul_i32 s97, s96, 112
    s_sub_u32 s95, s95, s97
    s_mul_i32 s95, s95, 14336
    s_lshl_b32 s96, s96, 7
    s_add_u32 s95, s95, s96
    s_and_b32 s94, s94, 1
    s_lshl_b32 s94, s94, 6
    s_add_u32 m0, s92, 6144
    s_add_u32 s95, s95, s94
    buffer_load_dwordx4 v9, s[44:47], s95 offen lds
    s_add_u32 s94, s93, 28
    s_lshr_b32 s95, s94, 1
    s_mul_hi_u32 s96, s95, 38347923
    s_mul_i32 s97, s96, 112
    s_sub_u32 s95, s95, s97
    s_mul_i32 s95, s95, 14336
    s_lshl_b32 s96, s96, 7
    s_add_u32 s95, s95, s96
    s_and_b32 s94, s94, 1
    s_lshl_b32 s94, s94, 6
    s_add_u32 m0, s92, 7168
    s_add_u32 s95, s95, s94
    buffer_load_dwordx4 v9, s[44:47], s95 offen lds
    s_add_u32 s94, s93, 32
    s_lshr_b32 s95, s94, 1
    s_mul_hi_u32 s96, s95, 38347923
    s_mul_i32 s97, s96, 112
    s_sub_u32 s95, s95, s97
    s_mul_i32 s95, s95, 14336
    s_lshl_b32 s96, s96, 7
    s_add_u32 s95, s95, s96
    s_and_b32 s94, s94, 1
    s_lshl_b32 s94, s94, 6
    s_add_u32 m0, s92, 8192
    s_add_u32 s95, s95, s94
    buffer_load_dwordx4 v9, s[44:47], s95 offen lds
    s_add_u32 s94, s93, 36
    s_lshr_b32 s95, s94, 1
    s_mul_hi_u32 s96, s95, 38347923
    s_mul_i32 s97, s96, 112
    s_sub_u32 s95, s95, s97
    s_mul_i32 s95, s95, 14336
    s_lshl_b32 s96, s96, 7
    s_add_u32 s95, s95, s96
    s_and_b32 s94, s94, 1
    s_lshl_b32 s94, s94, 6
    s_add_u32 m0, s92, 9216
    s_add_u32 s95, s95, s94
    buffer_load_dwordx4 v9, s[44:47], s95 offen lds
    s_add_u32 s94, s93, 40
    s_lshr_b32 s95, s94, 1
    s_mul_hi_u32 s96, s95, 38347923
    s_mul_i32 s97, s96, 112
    s_sub_u32 s95, s95, s97
    s_mul_i32 s95, s95, 14336
    s_lshl_b32 s96, s96, 7
    s_add_u32 s95, s95, s96
    s_and_b32 s94, s94, 1
    s_lshl_b32 s94, s94, 6
    s_add_u32 m0, s92, 10240
    s_add_u32 s95, s95, s94
    buffer_load_dwordx4 v9, s[44:47], s95 offen lds
    s_add_u32 s94, s93, 44
    s_lshr_b32 s95, s94, 1
    s_mul_hi_u32 s96, s95, 38347923
    s_mul_i32 s97, s96, 112
    s_sub_u32 s95, s95, s97
    s_mul_i32 s95, s95, 14336
    s_lshl_b32 s96, s96, 7
    s_add_u32 s95, s95, s96
    s_and_b32 s94, s94, 1
    s_lshl_b32 s94, s94, 6
    s_add_u32 m0, s92, 11264
    s_add_u32 s95, s95, s94
    buffer_load_dwordx4 v9, s[44:47], s95 offen lds
    s_cmp_lg_u32 s32, 0
    s_cbranch_scc1 Lrw_44
    s_add_u32 s94, s93, 48
    s_lshr_b32 s95, s94, 1
    s_mul_hi_u32 s96, s95, 38347923
    s_mul_i32 s97, s96, 112
    s_sub_u32 s95, s95, s97
    s_mul_i32 s95, s95, 14336
    s_lshl_b32 s96, s96, 7
    s_add_u32 s95, s95, s96
    s_and_b32 s94, s94, 1
    s_lshl_b32 s94, s94, 6
    s_add_u32 m0, s92, 12288
    s_add_u32 s95, s95, s94
    buffer_load_dwordx4 v9, s[44:47], s95 offen lds
Lrw_44:
    s_waitcnt vmcnt(0)
    ds_read_b64_tr_b16 v[16:17], v10 offset:0
    ds_read_b64_tr_b16 v[18:19], v10 offset:512
    ds_read_b64_tr_b16 v[20:21], v10 offset:1024
    ds_read_b64_tr_b16 v[22:23], v10 offset:1536
    ds_read_b64_tr_b16 v[24:25], v10 offset:2048
    ds_read_b64_tr_b16 v[26:27], v10 offset:2560
    ds_read_b64_tr_b16 v[28:29], v10 offset:3072
    ds_read_b64_tr_b16 v[30:31], v10 offset:3584
    ds_read_b64_tr_b16 v[32:33], v10 offset:4096
    ds_read_b64_tr_b16 v[34:35], v10 offset:4608
    ds_read_b64_tr_b16 v[36:37], v10 offset:5120
    ds_read_b64_tr_b16 v[38:39], v10 offset:5632
    ds_read_b64_tr_b16 v[40:41], v10 offset:6144
    ds_read_b64_tr_b16 v[42:43], v10 offset:6656
    ds_read_b64_tr_b16 v[44:45], v10 offset:7168
    ds_read_b64_tr_b16 v[46:47], v10 offset:7680
    ds_read_b64_tr_b16 v[48:49], v10 offset:8192
    ds_read_b64_tr_b16 v[50:51], v10 offset:8704
    ds_read_b64_tr_b16 v[52:53], v10 offset:9216
    ds_read_b64_tr_b16 v[54:55], v10 offset:9728
    ds_read_b64_tr_b16 v[56:57], v10 offset:10240
    ds_read_b64_tr_b16 v[58:59], v10 offset:10752
    ds_read_b64_tr_b16 v[60:61], v10 offset:11264
    ds_read_b64_tr_b16 v[62:63], v10 offset:11776
    ds_read_b64_tr_b16 v[64:65], v10 offset:12288
    ds_read_b64_tr_b16 v[66:67], v10 offset:12800
    s_lshl_b32 s93, s93, 10
    s_waitcnt lgkmcnt(0)
    s_add_u32 s94, s93, 0
    buffer_store_dwordx4 v[16:19], v5, s[48:51], s94 offen sc1
    s_add_u32 s94, s93, 4096
    buffer_store_dwordx4 v[20:23], v5, s[48:51], s94 offen sc1
    s_add_u32 s94, s93, 8192
    buffer_store_dwordx4 v[24:27], v5, s[48:51], s94 offen sc1
    s_add_u32 s94, s93, 12288
    buffer_store_dwordx4 v[28:31], v5, s[48:51], s94 offen sc1
    s_add_u32 s94, s93, 16384
    buffer_store_dwordx4 v[32:35], v5, s[48:51], s94 offen sc1
    s_add_u32 s94, s93, 20480
    buffer_store_dwordx4 v[36:39], v5, s[48:51], s94 offen sc1
    s_add_u32 s94, s93, 24576
    buffer_store_dwordx4 v[40:43], v5, s[48:51], s94 offen sc1
    s_add_u32 s94, s93, 28672
    buffer_store_dwordx4 v[44:47], v5, s[48:51], s94 offen sc1
    s_add_u32 s94, s93, 32768
    buffer_store_dwordx4 v[48:51], v5, s[48:51], s94 offen sc1
    s_add_u32 s94, s93, 36864
    buffer_store_dwordx4 v[52:55], v5, s[48:51], s94 offen sc1
    s_add_u32 s94, s93, 40960
    buffer_store_dwordx4 v[56:59], v5, s[48:51], s94 offen sc1
    s_add_u32 s94, s93, 45056
    buffer_store_dwordx4 v[60:63], v5, s[48:51], s94 offen sc1
    s_cmp_lg_u32 s32, 0
    s_cbranch_scc1 Lrw_45
    s_add_u32 s94, s93, 49152
    buffer_store_dwordx4 v[64:67], v5, s[48:51], s94 offen sc1
Lrw_45:
    s_cmp_lg_u32 s32, 0
    s_cbranch_scc1 Lwg_46
    s_mov_b32 s44, s28
    s_mov_b32 s45, s29
    s_mov_b32 s46, 256
    s_mov_b32 s47, 0x00020000
    v_and_b32 v8, 0x01000000, v4
    v_add_u32 v240, 1, v240
    v_add_u32 v241, 1, v241
    v_add_u32 v242, 1, v242
    v_add_u32 v243, 1, v243
    s_mov_b32 s3, 0
Lgl_47:
    buffer_load_dwordx4 v[248:251], v246, s[40:43], 0 offen sc1
    s_waitcnt vmcnt(0)
    v_xor_b32 v248, v248, v240
    v_xor_b32 v249, v249, v241
    v_xor_b32 v250, v250, v242
    v_xor_b32 v251, v251, v243
    v_bfi_b32 v251, v4, 0, v251
    v_or_b32 v248, v248, v249
    v_or3_b32 v248, v248, v250, v251
    v_cmp_ne_u32 vcc, 0, v248
    s_cbranch_vccz Lgd_48
    buffer_load_dword v1, v2, s[44:47], 0 offen sc1
    s_waitcnt vmcnt(0)
    v_or_b32 v1, v1, v8
    v_cmp_ne_u32 vcc, 0x01010101, v1
    s_cbranch_vccz Lgd_48
    s_sleep 8
    s_add_u32 s3, s3, 1
    s_cmp_lt_u32 s3, 200000
    s_cbranch_scc1 Lgl_47
Lgd_48:
Lwg_46:
    s_waitcnt vmcnt(0)
    s_barrier
Lej_43:
    s_cmp_lg_u32 s32, 0
    s_cbranch_scc1 Lpub_49
    v_mov_b32 v1, 2
    s_mov_b64 exec, 0xffff
    s_lshl_b32 s3, s37, 2
    v_lshl_add_u32 v15, v2, 8, s3
    buffer_store_dword v1, v15, s[40:43], 0 offen sc1
    s_mov_b64 exec, -1
Lpub_49:
    s_lshl_b32 s3, s33, 7
    s_add_u32 s3, s3, 20480
    v_min_u32 v8, 80, v2
    v_add_u32 v8, s3, v8
    s_mov_b32 s3, 0
Lslp_50:
    buffer_load_dword v1, v8, s[40:43], 0 offen sc1
    s_waitcnt vmcnt(0)
    v_cmp_gt_u32 vcc, 1, v1
    s_cbranch_vccz Lsdn_51
    s_sleep 1
    s_add_u32 s3, s3, 1
    s_cmp_lt_u32 s3, 200000
    s_cbranch_scc1 Lslp_50
Lsdn_51:
    s_add_u32 s44, s30, 4194304
    s_addc_u32 s45, s31, 0
    s_mov_b32 s46, 5376
    s_mov_b32 s47, 0x00020000
    buffer_load_dwordx4 v[216:219], v5, s[44:47], 0 offen offset:896 sc1
    buffer_load_dwordx4 v[220:223], v5, s[44:47], 0 offen offset:0 sc1
    buffer_load_dwordx4 v[224:227], v5, s[44:47], 0 offen offset:1792 sc1
    buffer_load_dwordx4 v[228:231], v5, s[44:47], 0 offen offset:3584 sc1
    buffer_load_dwordx4 v[232:235], v5, s[44:47], 0 offen offset:2688 sc1
    s_waitcnt vmcnt(0)
    v_lshlrev_b32 v16, 16, v208
    v_lshlrev_b32 v80, 16, v212
    v_and_b32 v17, 0xffff0000, v208
    v_and_b32 v81, 0xffff0000, v212
    v_lshlrev_b32 v18, 16, v209
    v_lshlrev_b32 v82, 16, v213
    v_and_b32 v19, 0xffff0000, v209
    v_and_b32 v83, 0xffff0000, v213
    v_lshlrev_b32 v20, 16, v210
    v_lshlrev_b32 v84, 16, v214
    v_and_b32 v21, 0xffff0000, v210
    v_and_b32 v85, 0xffff0000, v214
    v_lshlrev_b32 v22, 16, v211
    v_lshlrev_b32 v86, 16, v215
    v_and_b32 v23, 0xffff0000, v211
    v_and_b32 v87, 0xffff0000, v215
    s_nop 0
    s_nop 0
    v_readlane_b32 s92, v16, 0
    v_readlane_b32 s12, v80, 0
    s_nop 0
    s_nop 0
    s_mov_b32 s93, s92
    s_mov_b32 s13, s12
    s_nop 1
    s_nop 1
    v_pk_add_f32 v[32:33], v[16:17], s[92:93] neg_lo:[0,1] neg_hi:[0,1]
    v_pk_add_f32 v[96:97], v[80:81], s[12:13] neg_lo:[0,1] neg_hi:[0,1]
    v_pk_add_f32 v[34:35], v[18:19], s[92:93] neg_lo:[0,1] neg_hi:[0,1]
    v_pk_add_f32 v[98:99], v[82:83], s[12:13] neg_lo:[0,1] neg_hi:[0,1]
    v_pk_add_f32 v[36:37], v[20:21], s[92:93] neg_lo:[0,1] neg_hi:[0,1]
    v_pk_add_f32 v[100:101], v[84:85], s[12:13] neg_lo:[0,1] neg_hi:[0,1]
    v_pk_add_f32 v[38:39], v[22:23], s[92:93] neg_lo:[0,1] neg_hi:[0,1]
    v_pk_add_f32 v[102:103], v[86:87], s[12:13] neg_lo:[0,1] neg_hi:[0,1]
    v_pk_mul_f32 v[50:51], v[32:33], v[32:33]
    v_pk_mul_f32 v[114:115], v[96:97], v[96:97]
    v_pk_add_f32 v[48:49], v[32:33], v[34:35]
    v_pk_add_f32 v[112:113], v[96:97], v[98:99]
    v_pk_fma_f32 v[50:51], v[34:35], v[34:35], v[50:51]
    v_pk_fma_f32 v[114:115], v[98:99], v[98:99], v[114:115]
    v_pk_add_f32 v[48:49], v[48:49], v[36:37]
    v_pk_add_f32 v[112:113], v[112:113], v[100:101]
    v_pk_fma_f32 v[50:51], v[36:37], v[36:37], v[50:51]
    v_pk_fma_f32 v[114:115], v[100:101], v[100:101], v[114:115]
    v_pk_add_f32 v[48:49], v[48:49], v[38:39]
    v_pk_add_f32 v[112:113], v[112:113], v[102:103]
    v_pk_fma_f32 v[50:51], v[38:39], v[38:39], v[50:51]
    v_pk_fma_f32 v[114:115], v[102:103], v[102:103], v[114:115]
    v_add_f32 v48, v48, v49
    v_add_f32 v112, v112, v113
    v_add_f32 v50, v50, v51
    v_add_f32 v114, v114, v115
    v_cndmask_b32 v48, 0, v48, s[6:7]
    v_cndmask_b32 v112, 0, v112, s[6:7]
    v_cndmask_b32 v50, 0, v50, s[6:7]
    v_cndmask_b32 v114, 0, v114, s[6:7]
    s_nop 1
    s_nop 1
    v_add_f32 v48, v48, v48 quad_perm:[1,0,3,2] row_mask:0xf bank_mask:0xf
    v_add_f32 v112, v112, v112 quad_perm:[1,0,3,2] row_mask:0xf bank_mask:0xf
    v_add_f32 v50, v50, v50 quad_perm:[1,0,3,2] row_mask:0xf bank_mask:0xf
    v_add_f32 v114, v114, v114 quad_perm:[1,0,3,2] row_mask:0xf bank_mask:0xf
    s_nop 0
    s_nop 0
    v_add_f32 v48, v48, v48 quad_perm:[2,3,0,1] row_mask:0xf bank_mask:0xf
    v_add_f32 v112, v112, v112 quad_perm:[2,3,0,1] row_mask:0xf bank_mask:0xf
    v_add_f32 v50, v50, v50 quad_perm:[2,3,0,1] row_mask:0xf bank_mask:0xf
    v_add_f32 v114, v114, v114 quad_perm:[2,3,0,1] row_mask:0xf bank_mask:0xf
    s_nop 0
    s_nop 0
    v_add_f32 v48, v48, v48 row_half_mirror row_mask:0xf bank_mask:0xf
    v_add_f32 v112, v112, v112 row_half_mirror row_mask:0xf bank_mask:0xf
    v_add_f32 v50, v50, v50 row_half_mirror row_mask:0xf bank_mask:0xf
    v_add_f32 v114, v114, v114 row_half_mirror row_mask:0xf bank_mask:0xf
    s_nop 0
    s_nop 0
    v_add_f32 v48, v48, v48 row_mirror row_mask:0xf bank_mask:0xf
    v_add_f32 v112, v112, v112 row_mirror row_mask:0xf bank_mask:0xf
    v_add_f32 v50, v50, v50 row_mirror row_mask:0xf bank_mask:0xf
    v_add_f32 v114, v114, v114 row_mirror row_mask:0xf bank_mask:0xf
    s_nop 0
    s_nop 0
    v_add_f32 v48, v48, v48 row_bcast:15 row_mask:0xa bank_mask:0xf
    v_add_f32 v112, v112, v112 row_bcast:15 row_mask:0xa bank_mask:0xf
    v_add_f32 v50, v50, v50 row_bcast:15 row_mask:0xa bank_mask:0xf
    v_add_f32 v114, v114, v114 row_bcast:15 row_mask:0xa bank_mask:0xf
    s_nop 0
    s_nop 0
    v_add_f32 v48, v48, v48 row_bcast:31 row_mask:0xc bank_mask:0xf
    v_add_f32 v112, v112, v112 row_bcast:31 row_mask:0xc bank_mask:0xf
    v_add_f32 v50, v50, v50 row_bcast:31 row_mask:0xc bank_mask:0xf
    v_add_f32 v114, v114, v114 row_bcast:31 row_mask:0xc bank_mask:0xf
    s_nop 0
    s_nop 0
    v_readlane_b32 s94, v48, 63
    v_readlane_b32 s14, v112, 63
    v_readlane_b32 s95, v50, 63
    v_readlane_b32 s15, v114, 63
    s_nop 1
    s_nop 1
    v_mov_b32 v53, 0x3b124925
    v_mov_b32 v117, 0x3b124925
    v_mul_f32 v52, s94, v53
    v_mul_f32 v116, s14, v117
    v_mul_f32 v54, s95, v53
    v_mul_f32 v118, s15, v117
    v_fma_f32 v54, -v52, v52, v54
    v_fma_f32 v118, -v116, v116, v118
    v_add_f32 v52, s92, v52
    v_add_f32 v116, s12, v116
    v_max_f32 v54, 0, v54
    v_max_f32 v118, 0, v118
    v_cvt_pk_bf16_f32 v53, v52, v54
    v_cvt_pk_bf16_f32 v117, v116, v118
    v_lshlrev_b32 v52, 16, v53
    v_lshlrev_b32 v116, 16, v117
    v_and_b32 v54, 0xffff0000, v53
    v_and_b32 v118, 0xffff0000, v117
    v_add_f32 v54, 0x3727c5ac, v54
    v_add_f32 v118, 0x3727c5ac, v118
    v_cvt_pk_bf16_f32 v54, v54, v54
    v_cvt_pk_bf16_f32 v118, v118, v118
    v_lshlrev_b32 v54, 16, v54
    v_lshlrev_b32 v118, 16, v118
    v_sqrt_f32 v54, v54
    v_sqrt_f32 v118, v118
    v_pk_add_f32 v[24:25], v[16:17], v[52:53] op_sel_hi:[1,0] neg_lo:[0,1] neg_hi:[0,1]
    v_pk_add_f32 v[88:89], v[80:81], v[116:117] op_sel_hi:[1,0] neg_lo:[0,1] neg_hi:[0,1]
    v_pk_add_f32 v[26:27], v[18:19], v[52:53] op_sel_hi:[1,0] neg_lo:[0,1] neg_hi:[0,1]
    v_pk_add_f32 v[90:91], v[82:83], v[116:117] op_sel_hi:[1,0] neg_lo:[0,1] neg_hi:[0,1]
    v_pk_add_f32 v[28:29], v[20:21], v[52:53] op_sel_hi:[1,0] neg_lo:[0,1] neg_hi:[0,1]
    v_pk_add_f32 v[92:93], v[84:85], v[116:117] op_sel_hi:[1,0] neg_lo:[0,1] neg_hi:[0,1]
    v_pk_add_f32 v[30:31], v[22:23], v[52:53] op_sel_hi:[1,0] neg_lo:[0,1] neg_hi:[0,1]
    v_pk_add_f32 v[94:95], v[86:87], v[116:117] op_sel_hi:[1,0] neg_lo:[0,1] neg_hi:[0,1]
    v_cvt_pk_bf16_f32 v54, v54, v54
    v_cvt_pk_bf16_f32 v118, v118, v118
    v_lshlrev_b32 v54, 16, v54
    v_lshlrev_b32 v118, 16, v118
    v_rcp_f32 v54, v54
    v_rcp_f32 v118, v118
    v_cvt_pk_bf16_f32 v48, v24, v25
    v_cvt_pk_bf16_f32 v112, v88, v89
    v_cvt_pk_bf16_f32 v49, v26, v27
    v_cvt_pk_bf16_f32 v113, v90, v91
    v_cvt_pk_bf16_f32 v50, v28, v29
    v_cvt_pk_bf16_f32 v114, v92, v93
    v_cvt_pk_bf16_f32 v51, v30, v31
    v_cvt_pk_bf16_f32 v115, v94, v95
    v_lshlrev_b32 v24, 16, v48
    v_lshlrev_b32 v88, 16, v112
    v_and_b32 v25, 0xffff0000, v48
    v_and_b32 v89, 0xffff0000, v112
    v_lshlrev_b32 v26, 16, v49
    v_lshlrev_b32 v90, 16, v113
    v_and_b32 v27, 0xffff0000, v49
    v_and_b32 v91, 0xffff0000, v113
    v_lshlrev_b32 v28, 16, v50
    v_lshlrev_b32 v92, 16, v114
    v_and_b32 v29, 0xffff0000, v50
    v_and_b32 v93, 0xffff0000, v114
    v_lshlrev_b32 v30, 16, v51
    v_lshlrev_b32 v94, 16, v115
    v_and_b32 v31, 0xffff0000, v51
    v_and_b32 v95, 0xffff0000, v115
    v_pk_mul_f32 v[24:25], v[24:25], v[54:55] op_sel_hi:[1,0]
    v_pk_mul_f32 v[88:89], v[88:89], v[118:119] op_sel_hi:[1,0]
    v_pk_mul_f32 v[26:27], v[26:27], v[54:55] op_sel_hi:[1,0]
    v_pk_mul_f32 v[90:91], v[90:91], v[118:119] op_sel_hi:[1,0]
    v_pk_mul_f32 v[28:29], v[28:29], v[54:55] op_sel_hi:[1,0]
    v_pk_mul_f32 v[92:93], v[92:93], v[118:119] op_sel_hi:[1,0]
    v_pk_mul_f32 v[30:31], v[30:31], v[54:55] op_sel_hi:[1,0]
    v_pk_mul_f32 v[94:95], v[94:95], v[118:119] op_sel_hi:[1,0]
    v_cvt_pk_bf16_f32 v48, v24, v25
    v_cvt_pk_bf16_f32 v112, v88, v89
    v_cvt_pk_bf16_f32 v49, v26, v27
    v_cvt_pk_bf16_f32 v113, v90, v91
    v_cvt_pk_bf16_f32 v50, v28, v29
    v_cvt_pk_bf16_f32 v114, v92, v93
    v_cvt_pk_bf16_f32 v51, v30, v31
    v_cvt_pk_bf16_f32 v115, v94, v95
    v_lshlrev_b32 v24, 16, v48
    v_lshlrev_b32 v88, 16, v112
    v_and_b32 v25, 0xffff0000, v48
    v_and_b32 v89, 0xffff0000, v112
    v_lshlrev_b32 v26, 16, v49
    v_lshlrev_b32 v90, 16, v113
    v_and_b32 v27, 0xffff0000, v49
    v_and_b32 v91, 0xffff0000, v113
    v_lshlrev_b32 v28, 16, v50
    v_lshlrev_b32 v92, 16, v114
    v_and_b32 v29, 0xffff0000, v50
    v_and_b32 v93, 0xffff0000, v114
    v_lshlrev_b32 v30, 16, v51
    v_lshlrev_b32 v94, 16, v115
    v_and_b32 v31, 0xffff0000, v51
    v_and_b32 v95, 0xffff0000, v115
    v_lshlrev_b32 v40, 16, v216
    v_lshlrev_b32 v104, 16, v216
    v_and_b32 v41, 0xffff0000, v216
    v_and_b32 v105, 0xffff0000, v216
    v_lshlrev_b32 v42, 16, v217
    v_lshlrev_b32 v106, 16, v217
    v_and_b32 v43, 0xffff0000, v217
    v_and_b32 v107, 0xffff0000, v217
    v_lshlrev_b32 v44, 16, v218
    v_lshlrev_b32 v108, 16, v218
    v_and_b32 v45, 0xffff0000, v218
    v_and_b32 v109, 0xffff0000, v218
    v_lshlrev_b32 v46, 16, v219
    v_lshlrev_b32 v110, 16, v219
    v_and_b32 v47, 0xffff0000, v219
    v_and_b32 v111, 0xffff0000, v219
    v_pk_mul_f32 v[24:25], v[24:25], v[40:41]
    v_pk_mul_f32 v[88:89], v[88:89], v[104:105]
    v_pk_mul_f32 v[26:27], v[26:27], v[42:43]
    v_pk_mul_f32 v[90:91], v[90:91], v[106:107]
    v_pk_mul_f32 v[28:29], v[28:29], v[44:45]
    v_pk_mul_f32 v[92:93], v[92:93], v[108:109]
    v_pk_mul_f32 v[30:31], v[30:31], v[46:47]
    v_pk_mul_f32 v[94:95], v[94:95], v[110:111]
    v_lshlrev_b32 v40, 16, v220
    v_lshlrev_b32 v104, 16, v220
    v_and_b32 v41, 0xffff0000, v220
    v_and_b32 v105, 0xffff0000, v220
    v_lshlrev_b32 v42, 16, v221
    v_lshlrev_b32 v106, 16, v221
    v_and_b32 v43, 0xffff0000, v221
    v_and_b32 v107, 0xffff0000, v221
    v_lshlrev_b32 v44, 16, v222
    v_lshlrev_b32 v108, 16, v222
    v_and_b32 v45, 0xffff0000, v222
    v_and_b32 v109, 0xffff0000, v222
    v_lshlrev_b32 v46, 16, v223
    v_lshlrev_b32 v110, 16, v223
    v_and_b32 v47, 0xffff0000, v223
    v_and_b32 v111, 0xffff0000, v223
    v_cvt_pk_bf16_f32 v48, v24, v25
    v_cvt_pk_bf16_f32 v112, v88, v89
    v_cvt_pk_bf16_f32 v49, v26, v27
    v_cvt_pk_bf16_f32 v113, v90, v91
    v_cvt_pk_bf16_f32 v50, v28, v29
    v_cvt_pk_bf16_f32 v114, v92, v93
    v_cvt_pk_bf16_f32 v51, v30, v31
    v_cvt_pk_bf16_f32 v115, v94, v95
    v_lshlrev_b32 v24, 16, v48
    v_lshlrev_b32 v88, 16, v112
    v_and_b32 v25, 0xffff0000, v48
    v_and_b32 v89, 0xffff0000, v112
    v_lshlrev_b32 v26, 16, v49
    v_lshlrev_b32 v90, 16, v113
    v_and_b32 v27, 0xffff0000, v49
    v_and_b32 v91, 0xffff0000, v113
    v_lshlrev_b32 v28, 16, v50
    v_lshlrev_b32 v92, 16, v114
    v_and_b32 v29, 0xffff0000, v50
    v_and_b32 v93, 0xffff0000, v114
    v_lshlrev_b32 v30, 16, v51
    v_lshlrev_b32 v94, 16, v115
    v_and_b32 v31, 0xffff0000, v51
    v_and_b32 v95, 0xffff0000, v115
    v_pk_add_f32 v[24:25], v[24:25], v[40:41]
    v_pk_add_f32 v[88:89], v[88:89], v[104:105]
    v_pk_add_f32 v[26:27], v[26:27], v[42:43]
    v_pk_add_f32 v[90:91], v[90:91], v[106:107]
    v_pk_add_f32 v[28:29], v[28:29], v[44:45]
    v_pk_add_f32 v[92:93], v[92:93], v[108:109]
    v_pk_add_f32 v[30:31], v[30:31], v[46:47]
    v_pk_add_f32 v[94:95], v[94:95], v[110:111]
    v_cvt_pk_bf16_f32 v48, v24, v25
    v_cvt_pk_bf16_f32 v112, v88, v89
    v_cvt_pk_bf16_f32 v49, v26, v27
    v_cvt_pk_bf16_f32 v113, v90, v91
    v_cvt_pk_bf16_f32 v50, v28, v29
    v_cvt_pk_bf16_f32 v114, v92, v93
    v_cvt_pk_bf16_f32 v51, v30, v31
    v_cvt_pk_bf16_f32 v115, v94, v95
    v_lshlrev_b32 v24, 16, v48
    v_lshlrev_b32 v88, 16, v112
    v_and_b32 v25, 0xffff0000, v48
    v_and_b32 v89, 0xffff0000, v112
    v_lshlrev_b32 v26, 16, v49
    v_lshlrev_b32 v90, 16, v113
    v_and_b32 v27, 0xffff0000, v49
    v_and_b32 v91, 0xffff0000, v113
    v_lshlrev_b32 v28, 16, v50
    v_lshlrev_b32 v92, 16, v114
    v_and_b32 v29, 0xffff0000, v50
    v_and_b32 v93, 0xffff0000, v114
    v_lshlrev_b32 v30, 16, v51
    v_lshlrev_b32 v94, 16, v115
    v_and_b32 v31, 0xffff0000, v51
    v_and_b32 v95, 0xffff0000, v115
    s_cmp_lg_u32 s32, 0
    s_cbranch_scc1 Ls0_52
    s_lshl_b32 s3, s33, 10
    v_add_u32 v8, s3, v5
    s_mov_b32 s3, 0
Lslp_53:
    buffer_load_dwordx4 v[12:15], v8, s[40:43], 0 offen sc1
    s_waitcnt vmcnt(0)
    v_min_u32 v12, v12, v13
    v_min3_u32 v12, v12, v14, v15
    v_cmp_gt_u32 vcc, s11, v12
    s_cbranch_vccz Lsdn_54
    s_sleep 1
    s_add_u32 s3, s3, 1
    s_cmp_lt_u32 s3, 200000
    s_cbranch_scc1 Lslp_53
Lsdn_54:
Ls0_52:
    s_barrier
    s_lshr_b32 s92, s100, 6
    s_mul_i32 s92, s92, 57344
    s_lshl_b32 s93, s35, 4
    s_add_u32 s92, s92, s93
    v_lshlrev_b32 v8, 7, v0
    v_add_u32 v8, s92, v8
    s_add_u32 s44, s30, 2097152
    s_addc_u32 s45, s31, 0
    s_mov_b32 s46, 1835008
    s_mov_b32 s47, 0x00020000
    s_mov_b32 s93, 32768
    buffer_load_dwordx4 v[144:147], v8, s[44:47], 0 offen sc1
    buffer_load_dwordx4 v[148:151], v8, s[44:47], s93 offen sc1
    s_add_u32 s44, s30, 5242880
    s_addc_u32 s45, s31, 0
    s_mov_b32 s46, 1835008
    s_mov_b32 s47, 0x00020000
    s_add_u32 s48, s30, 7340032
    s_addc_u32 s49, s31, 0
    s_mov_b32 s50, 1835008
    s_mov_b32 s51, 0x00020000
    v_lshlrev_b32 v8, 1, v0
    s_mul_i32 s92, s32, 1824
    v_add_u32 v9, s92, v5
    v_and_b32 v10, 7, v0
    v_lshrrev_b32 v11, 3, v0
    v_mul_u32_u24 v12, 912, v10
    v_lshl_add_u32 v12, v11, 4, v12
    s_lshr_b32 s92, s100, 5
    s_mul_i32 s92, s92, 28672
    s_and_b32 s93, s100, 31
    s_lshl_b32 s93, s93, 4
    s_add_u32 s92, s92, s93
    v_lshlrev_b32 v11, 9, v11
    v_lshl_add_u32 v11, v10, 4, v11
    v_add_u32 v11, s92, v11
    s_waitcnt vmcnt(0)
    ds_write_b16 v8, v144 offset:0
    ds_write_b16_d16_hi v8, v144 offset:912
    ds_write_b16 v8, v145 offset:1824
    ds_write_b16_d16_hi v8, v145 offset:2736
    ds_write_b16 v8, v146 offset:3648
    ds_write_b16_d16_hi v8, v146 offset:4560
    ds_write_b16 v8, v147 offset:5472
    ds_write_b16_d16_hi v8, v147 offset:6384
    s_cmp_eq_u32 s32, 3
    s_cbranch_scc1 Lys_55
    ds_write_b16 v8, v148 offset:512
    ds_write_b16_d16_hi v8, v148 offset:1424
    ds_write_b16 v8, v149 offset:2336
    ds_write_b16_d16_hi v8, v149 offset:3248
    ds_write_b16 v8, v150 offset:4160
    ds_write_b16_d16_hi v8, v150 offset:5072
    ds_write_b16 v8, v151 offset:5984
    ds_write_b16_d16_hi v8, v151 offset:6896
Lys_55:
    s_waitcnt lgkmcnt(0)
    s_barrier
    ds_read_b128 v[64:67], v9 offset:0
    ds_read_b128 v[128:131], v9 offset:912
    s_waitcnt lgkmcnt(0)
    v_lshlrev_b32 v40, 16, v64
    v_lshlrev_b32 v104, 16, v128
    v_and_b32 v41, 0xffff0000, v64
    v_and_b32 v105, 0xffff0000, v128
    v_lshlrev_b32 v42, 16, v65
    v_lshlrev_b32 v106, 16, v129
    v_and_b32 v43, 0xffff0000, v65
    v_and_b32 v107, 0xffff0000, v129
    v_lshlrev_b32 v44, 16, v66
    v_lshlrev_b32 v108, 16, v130
    v_and_b32 v45, 0xffff0000, v66
    v_and_b32 v109, 0xffff0000, v130
    v_lshlrev_b32 v46, 16, v67
    v_lshlrev_b32 v110, 16, v131
    v_and_b32 v47, 0xffff0000, v67
    v_and_b32 v111, 0xffff0000, v131
    v_pk_mul_f32 v[24:25], v[24:25], v[40:41]
    v_pk_mul_f32 v[88:89], v[88:89], v[104:105]
    v_pk_mul_f32 v[26:27], v[26:27], v[42:43]
    v_pk_mul_f32 v[90:91], v[90:91], v[106:107]
    v_pk_mul_f32 v[28:29], v[28:29], v[44:45]
    v_pk_mul_f32 v[92:93], v[92:93], v[108:109]
    v_pk_mul_f32 v[30:31], v[30:31], v[46:47]
    v_pk_mul_f32 v[94:95], v[94:95], v[110:111]
    v_lshlrev_b32 v40, 16, v224
    v_lshlrev_b32 v104, 16, v224
    v_and_b32 v41, 0xffff0000, v224
    v_and_b32 v105, 0xffff0000, v224
    v_lshlrev_b32 v42, 16, v225
    v_lshlrev_b32 v106, 16, v225
    v_and_b32 v43, 0xffff0000, v225
    v_and_b32 v107, 0xffff0000, v225
    v_lshlrev_b32 v44, 16, v226
    v_lshlrev_b32 v108, 16, v226
    v_and_b32 v45, 0xffff0000, v226
    v_and_b32 v109, 0xffff0000, v226
    v_lshlrev_b32 v46, 16, v227
    v_lshlrev_b32 v110, 16, v227
    v_and_b32 v47, 0xffff0000, v227
    v_and_b32 v111, 0xffff0000, v227
    v_cvt_pk_bf16_f32 v48, v24, v25
    v_cvt_pk_bf16_f32 v112, v88, v89
    v_cvt_pk_bf16_f32 v49, v26, v27
    v_cvt_pk_bf16_f32 v113, v90, v91
    v_cvt_pk_bf16_f32 v50, v28, v29
    v_cvt_pk_bf16_f32 v114, v92, v93
    v_cvt_pk_bf16_f32 v51, v30, v31
    v_cvt_pk_bf16_f32 v115, v94, v95
    v_lshlrev_b32 v24, 16, v48
    v_lshlrev_b32 v88, 16, v112
    v_and_b32 v25, 0xffff0000, v48
    v_and_b32 v89, 0xffff0000, v112
    v_lshlrev_b32 v26, 16, v49
    v_lshlrev_b32 v90, 16, v113
    v_and_b32 v27, 0xffff0000, v49
    v_and_b32 v91, 0xffff0000, v113
    v_lshlrev_b32 v28, 16, v50
    v_lshlrev_b32 v92, 16, v114
    v_and_b32 v29, 0xffff0000, v50
    v_and_b32 v93, 0xffff0000, v114
    v_lshlrev_b32 v30, 16, v51
    v_lshlrev_b32 v94, 16, v115
    v_and_b32 v31, 0xffff0000, v51
    v_and_b32 v95, 0xffff0000, v115
    v_pk_mul_f32 v[24:25], v[24:25], v[40:41]
    v_pk_mul_f32 v[88:89], v[88:89], v[104:105]
    v_pk_mul_f32 v[26:27], v[26:27], v[42:43]
    v_pk_mul_f32 v[90:91], v[90:91], v[106:107]
    v_pk_mul_f32 v[28:29], v[28:29], v[44:45]
    v_pk_mul_f32 v[92:93], v[92:93], v[108:109]
    v_pk_mul_f32 v[30:31], v[30:31], v[46:47]
    v_pk_mul_f32 v[94:95], v[94:95], v[110:111]
    v_cvt_pk_bf16_f32 v48, v24, v25
    v_cvt_pk_bf16_f32 v112, v88, v89
    v_cvt_pk_bf16_f32 v49, v26, v27
    v_cvt_pk_bf16_f32 v113, v90, v91
    v_cvt_pk_bf16_f32 v50, v28, v29
    v_cvt_pk_bf16_f32 v114, v92, v93
    v_cvt_pk_bf16_f32 v51, v30, v31
    v_cvt_pk_bf16_f32 v115, v94, v95
    v_lshlrev_b32 v24, 16, v48
    v_lshlrev_b32 v88, 16, v112
    v_and_b32 v25, 0xffff0000, v48
    v_and_b32 v89, 0xffff0000, v112
    v_lshlrev_b32 v26, 16, v49
    v_lshlrev_b32 v90, 16, v113
    v_and_b32 v27, 0xffff0000, v49
    v_and_b32 v91, 0xffff0000, v113
    v_lshlrev_b32 v28, 16, v50
    v_lshlrev_b32 v92, 16, v114
    v_and_b32 v29, 0xffff0000, v50
    v_and_b32 v93, 0xffff0000, v114
    v_lshlrev_b32 v30, 16, v51
    v_lshlrev_b32 v94, 16, v115
    v_and_b32 v31, 0xffff0000, v51
    v_and_b32 v95, 0xffff0000, v115
    v_pk_add_f32 v[16:17], v[16:17], v[24:25]
    v_pk_add_f32 v[80:81], v[80:81], v[88:89]
    v_pk_add_f32 v[18:19], v[18:19], v[26:27]
    v_pk_add_f32 v[82:83], v[82:83], v[90:91]
    v_pk_add_f32 v[20:21], v[20:21], v[28:29]
    v_pk_add_f32 v[84:85], v[84:85], v[92:93]
    v_pk_add_f32 v[22:23], v[22:23], v[30:31]
    v_pk_add_f32 v[86:87], v[86:87], v[94:95]
    v_cvt_pk_bf16_f32 v56, v16, v17
    v_cvt_pk_bf16_f32 v120, v80, v81
    v_cvt_pk_bf16_f32 v57, v18, v19
    v_cvt_pk_bf16_f32 v121, v82, v83
    v_cvt_pk_bf16_f32 v58, v20, v21
    v_cvt_pk_bf16_f32 v122, v84, v85
    v_cvt_pk_bf16_f32 v59, v22, v23
    v_cvt_pk_bf16_f32 v123, v86, v87
    v_lshlrev_b32 v16, 16, v56
    v_lshlrev_b32 v80, 16, v120
    v_and_b32 v17, 0xffff0000, v56
    v_and_b32 v81, 0xffff0000, v120
    v_lshlrev_b32 v18, 16, v57
    v_lshlrev_b32 v82, 16, v121
    v_and_b32 v19, 0xffff0000, v57
    v_and_b32 v83, 0xffff0000, v121
    v_lshlrev_b32 v20, 16, v58
    v_lshlrev_b32 v84, 16, v122
    v_and_b32 v21, 0xffff0000, v58
    v_and_b32 v85, 0xffff0000, v122
    v_lshlrev_b32 v22, 16, v59
    v_lshlrev_b32 v86, 16, v123
    v_and_b32 v23, 0xffff0000, v59
    v_and_b32 v87, 0xffff0000, v123
    s_nop 0
    s_nop 0
    v_readlane_b32 s92, v16, 0
    v_readlane_b32 s12, v80, 0
    s_nop 0
    s_nop 0
    s_mov_b32 s93, s92
    s_mov_b32 s13, s12
    s_nop 1
    s_nop 1
    v_pk_add_f32 v[32:33], v[16:17], s[92:93] neg_lo:[0,1] neg_hi:[0,1]
    v_pk_add_f32 v[96:97], v[80:81], s[12:13] neg_lo:[0,1] neg_hi:[0,1]
    v_pk_add_f32 v[34:35], v[18:19], s[92:93] neg_lo:[0,1] neg_hi:[0,1]
    v_pk_add_f32 v[98:99], v[82:83], s[12:13] neg_lo:[0,1] neg_hi:[0,1]
    v_pk_add_f32 v[36:37], v[20:21], s[92:93] neg_lo:[0,1] neg_hi:[0,1]
    v_pk_add_f32 v[100:101], v[84:85], s[12:13] neg_lo:[0,1] neg_hi:[0,1]
    v_pk_add_f32 v[38:39], v[22:23], s[92:93] neg_lo:[0,1] neg_hi:[0,1]
    v_pk_add_f32 v[102:103], v[86:87], s[12:13] neg_lo:[0,1] neg_hi:[0,1]
    v_pk_mul_f32 v[50:51], v[32:33], v[32:33]
    v_pk_mul_f32 v[114:115], v[96:97], v[96:97]
    v_pk_add_f32 v[48:49], v[32:33], v[34:35]
    v_pk_add_f32 v[112:113], v[96:97], v[98:99]
    v_pk_fma_f32 v[50:51], v[34:35], v[34:35], v[50:51]
    v_pk_fma_f32 v[114:115], v[98:99], v[98:99], v[114:115]
    v_pk_add_f32 v[48:49], v[48:49], v[36:37]
    v_pk_add_f32 v[112:113], v[112:113], v[100:101]
    v_pk_fma_f32 v[50:51], v[36:37], v[36:37], v[50:51]
    v_pk_fma_f32 v[114:115], v[100:101], v[100:101], v[114:115]
    v_pk_add_f32 v[48:49], v[48:49], v[38:39]
    v_pk_add_f32 v[112:113], v[112:113], v[102:103]
    v_pk_fma_f32 v[50:51], v[38:39], v[38:39], v[50:51]
    v_pk_fma_f32 v[114:115], v[102:103], v[102:103], v[114:115]
    v_add_f32 v48, v48, v49
    v_add_f32 v112, v112, v113
    v_add_f32 v50, v50, v51
    v_add_f32 v114, v114, v115
    v_cndmask_b32 v48, 0, v48, s[6:7]
    v_cndmask_b32 v112, 0, v112, s[6:7]
    v_cndmask_b32 v50, 0, v50, s[6:7]
    v_cndmask_b32 v114, 0, v114, s[6:7]
    s_nop 1
    s_nop 1
    v_add_f32 v48, v48, v48 quad_perm:[1,0,3,2] row_mask:0xf bank_mask:0xf
    v_add_f32 v112, v112, v112 quad_perm:[1,0,3,2] row_mask:0xf bank_mask:0xf
    v_add_f32 v50, v50, v50 quad_perm:[1,0,3,2] row_mask:0xf bank_mask:0xf
    v_add_f32 v114, v114, v114 quad_perm:[1,0,3,2] row_mask:0xf bank_mask:0xf
    s_nop 0
    s_nop 0
    v_add_f32 v48, v48, v48 quad_perm:[2,3,0,1] row_mask:0xf bank_mask:0xf
    v_add_f32 v112, v112, v112 quad_perm:[2,3,0,1] row_mask:0xf bank_mask:0xf
    v_add_f32 v50, v50, v50 quad_perm:[2,3,0,1] row_mask:0xf bank_mask:0xf
    v_add_f32 v114, v114, v114 quad_perm:[2,3,0,1] row_mask:0xf bank_mask:0xf
    s_nop 0
    s_nop 0
    v_add_f32 v48, v48, v48 row_half_mirror row_mask:0xf bank_mask:0xf
    v_add_f32 v112, v112, v112 row_half_mirror row_mask:0xf bank_mask:0xf
    v_add_f32 v50, v50, v50 row_half_mirror row_mask:0xf bank_mask:0xf
    v_add_f32 v114, v114, v114 row_half_mirror row_mask:0xf bank_mask:0xf
    s_nop 0
    s_nop 0
    v_add_f32 v48, v48, v48 row_mirror row_mask:0xf bank_mask:0xf
    v_add_f32 v112, v112, v112 row_mirror row_mask:0xf bank_mask:0xf
    v_add_f32 v50, v50, v50 row_mirror row_mask:0xf bank_mask:0xf
    v_add_f32 v114, v114, v114 row_mirror row_mask:0xf bank_mask:0xf
    s_nop 0
    s_nop 0
    v_add_f32 v48, v48, v48 row_bcast:15 row_mask:0xa bank_mask:0xf
    v_add_f32 v112, v112, v112 row_bcast:15 row_mask:0xa bank_mask:0xf
    v_add_f32 v50, v50, v50 row_bcast:15 row_mask:0xa bank_mask:0xf
    v_add_f32 v114, v114, v114 row_bcast:15 row_mask:0xa bank_mask:0xf
    s_nop 0
    s_nop 0
    v_add_f32 v48, v48, v48 row_bcast:31 row_mask:0xc bank_mask:0xf
    v_add_f32 v112, v112, v112 row_bcast:31 row_mask:0xc bank_mask:0xf
    v_add_f32 v50, v50, v50 row_bcast:31 row_mask:0xc bank_mask:0xf
    v_add_f32 v114, v114, v114 row_bcast:31 row_mask:0xc bank_mask:0xf
    s_nop 0
    s_nop 0
    v_readlane_b32 s94, v48, 63
    v_readlane_b32 s14, v112, 63
    v_readlane_b32 s95, v50, 63
    v_readlane_b32 s15, v114, 63
    s_nop 1
    s_nop 1
    v_mov_b32 v53, 0x3b124925
    v_mov_b32 v117, 0x3b124925
    v_mul_f32 v52, s94, v53
    v_mul_f32 v116, s14, v117
    v_mul_f32 v54, s95, v53
    v_mul_f32 v118, s15, v117
    v_fma_f32 v54, -v52, v52, v54
    v_fma_f32 v118, -v116, v116, v118
    v_add_f32 v52, s92, v52
    v_add_f32 v116, s12, v116
    v_max_f32 v54, 0, v54
    v_max_f32 v118, 0, v118
    v_cvt_pk_bf16_f32 v53, v52, v54
    v_cvt_pk_bf16_f32 v117, v116, v118
    v_lshlrev_b32 v52, 16, v53
    v_lshlrev_b32 v116, 16, v117
    v_and_b32 v54, 0xffff0000, v53
    v_and_b32 v118, 0xffff0000, v117
    v_add_f32 v54, 0x3727c5ac, v54
    v_add_f32 v118, 0x3727c5ac, v118
    v_cvt_pk_bf16_f32 v54, v54, v54
    v_cvt_pk_bf16_f32 v118, v118, v118
    v_lshlrev_b32 v54, 16, v54
    v_lshlrev_b32 v118, 16, v118
    v_sqrt_f32 v54, v54
    v_sqrt_f32 v118, v118
    v_pk_add_f32 v[24:25], v[16:17], v[52:53] op_sel_hi:[1,0] neg_lo:[0,1] neg_hi:[0,1]
    v_pk_add_f32 v[88:89], v[80:81], v[116:117] op_sel_hi:[1,0] neg_lo:[0,1] neg_hi:[0,1]
    v_pk_add_f32 v[26:27], v[18:19], v[52:53] op_sel_hi:[1,0] neg_lo:[0,1] neg_hi:[0,1]
    v_pk_add_f32 v[90:91], v[82:83], v[116:117] op_sel_hi:[1,0] neg_lo:[0,1] neg_hi:[0,1]
    v_pk_add_f32 v[28:29], v[20:21], v[52:53] op_sel_hi:[1,0] neg_lo:[0,1] neg_hi:[0,1]
    v_pk_add_f32 v[92:93], v[84:85], v[116:117] op_sel_hi:[1,0] neg_lo:[0,1] neg_hi:[0,1]
    v_pk_add_f32 v[30:31], v[22:23], v[52:53] op_sel_hi:[1,0] neg_lo:[0,1] neg_hi:[0,1]
    v_pk_add_f32 v[94:95], v[86:87], v[116:117] op_sel_hi:[1,0] neg_lo:[0,1] neg_hi:[0,1]
    v_cvt_pk_bf16_f32 v54, v54, v54
    v_cvt_pk_bf16_f32 v118, v118, v118
    v_lshlrev_b32 v54, 16, v54
    v_lshlrev_b32 v118, 16, v118
    v_rcp_f32 v54, v54
    v_rcp_f32 v118, v118
    v_cvt_pk_bf16_f32 v48, v24, v25
    v_cvt_pk_bf16_f32 v112, v88, v89
    v_cvt_pk_bf16_f32 v49, v26, v27
    v_cvt_pk_bf16_f32 v113, v90, v91
    v_cvt_pk_bf16_f32 v50, v28, v29
    v_cvt_pk_bf16_f32 v114, v92, v93
    v_cvt_pk_bf16_f32 v51, v30, v31
    v_cvt_pk_bf16_f32 v115, v94, v95
    v_lshlrev_b32 v24, 16, v48
    v_lshlrev_b32 v88, 16, v112
    v_and_b32 v25, 0xffff0000, v48
    v_and_b32 v89, 0xffff0000, v112
    v_lshlrev_b32 v26, 16, v49
    v_lshlrev_b32 v90, 16, v113
    v_and_b32 v27, 0xffff0000, v49
    v_and_b32 v91, 0xffff0000, v113
    v_lshlrev_b32 v28, 16, v50
    v_lshlrev_b32 v92, 16, v114
    v_and_b32 v29, 0xffff0000, v50
    v_and_b32 v93, 0xffff0000, v114
    v_lshlrev_b32 v30, 16, v51
    v_lshlrev_b32 v94, 16, v115
    v_and_b32 v31, 0xffff0000, v51
    v_and_b32 v95, 0xffff0000, v115
    v_pk_mul_f32 v[24:25], v[24:25], v[54:55] op_sel_hi:[1,0]
    v_pk_mul_f32 v[88:89], v[88:89], v[118:119] op_sel_hi:[1,0]
    v_pk_mul_f32 v[26:27], v[26:27], v[54:55] op_sel_hi:[1,0]
    v_pk_mul_f32 v[90:91], v[90:91], v[118:119] op_sel_hi:[1,0]
    v_pk_mul_f32 v[28:29], v[28:29], v[54:55] op_sel_hi:[1,0]
    v_pk_mul_f32 v[92:93], v[92:93], v[118:119] op_sel_hi:[1,0]
    v_pk_mul_f32 v[30:31], v[30:31], v[54:55] op_sel_hi:[1,0]
    v_pk_mul_f32 v[94:95], v[94:95], v[118:119] op_sel_hi:[1,0]
    v_cvt_pk_bf16_f32 v48, v24, v25
    v_cvt_pk_bf16_f32 v112, v88, v89
    v_cvt_pk_bf16_f32 v49, v26, v27
    v_cvt_pk_bf16_f32 v113, v90, v91
    v_cvt_pk_bf16_f32 v50, v28, v29
    v_cvt_pk_bf16_f32 v114, v92, v93
    v_cvt_pk_bf16_f32 v51, v30, v31
    v_cvt_pk_bf16_f32 v115, v94, v95
    v_lshlrev_b32 v24, 16, v48
    v_lshlrev_b32 v88, 16, v112
    v_and_b32 v25, 0xffff0000, v48
    v_and_b32 v89, 0xffff0000, v112
    v_lshlrev_b32 v26, 16, v49
    v_lshlrev_b32 v90, 16, v113
    v_and_b32 v27, 0xffff0000, v49
    v_and_b32 v91, 0xffff0000, v113
    v_lshlrev_b32 v28, 16, v50
    v_lshlrev_b32 v92, 16, v114
    v_and_b32 v29, 0xffff0000, v50
    v_and_b32 v93, 0xffff0000, v114
    v_lshlrev_b32 v30, 16, v51
    v_lshlrev_b32 v94, 16, v115
    v_and_b32 v31, 0xffff0000, v51
    v_and_b32 v95, 0xffff0000, v115
    v_lshlrev_b32 v40, 16, v228
    v_lshlrev_b32 v104, 16, v228
    v_and_b32 v41, 0xffff0000, v228
    v_and_b32 v105, 0xffff0000, v228
    v_lshlrev_b32 v42, 16, v229
    v_lshlrev_b32 v106, 16, v229
    v_and_b32 v43, 0xffff0000, v229
    v_and_b32 v107, 0xffff0000, v229
    v_lshlrev_b32 v44, 16, v230
    v_lshlrev_b32 v108, 16, v230
    v_and_b32 v45, 0xffff0000, v230
    v_and_b32 v109, 0xffff0000, v230
    v_lshlrev_b32 v46, 16, v231
    v_lshlrev_b32 v110, 16, v231
    v_and_b32 v47, 0xffff0000, v231
    v_and_b32 v111, 0xffff0000, v231
    v_pk_mul_f32 v[24:25], v[24:25], v[40:41]
    v_pk_mul_f32 v[88:89], v[88:89], v[104:105]
    v_pk_mul_f32 v[26:27], v[26:27], v[42:43]
    v_pk_mul_f32 v[90:91], v[90:91], v[106:107]
    v_pk_mul_f32 v[28:29], v[28:29], v[44:45]
    v_pk_mul_f32 v[92:93], v[92:93], v[108:109]
    v_pk_mul_f32 v[30:31], v[30:31], v[46:47]
    v_pk_mul_f32 v[94:95], v[94:95], v[110:111]
    v_lshlrev_b32 v40, 16, v232
    v_lshlrev_b32 v104, 16, v232
    v_and_b32 v41, 0xffff0000, v232
    v_and_b32 v105, 0xffff0000, v232
    v_lshlrev_b32 v42, 16, v233
    v_lshlrev_b32 v106, 16, v233
    v_and_b32 v43, 0xffff0000, v233
    v_and_b32 v107, 0xffff0000, v233
    v_lshlrev_b32 v44, 16, v234
    v_lshlrev_b32 v108, 16, v234
    v_and_b32 v45, 0xffff0000, v234
    v_and_b32 v109, 0xffff0000, v234
    v_lshlrev_b32 v46, 16, v235
    v_lshlrev_b32 v110, 16, v235
    v_and_b32 v47, 0xffff0000, v235
    v_and_b32 v111, 0xffff0000, v235
    v_cvt_pk_bf16_f32 v48, v24, v25
    v_cvt_pk_bf16_f32 v112, v88, v89
    v_cvt_pk_bf16_f32 v49, v26, v27
    v_cvt_pk_bf16_f32 v113, v90, v91
    v_cvt_pk_bf16_f32 v50, v28, v29
    v_cvt_pk_bf16_f32 v114, v92, v93
    v_cvt_pk_bf16_f32 v51, v30, v31
    v_cvt_pk_bf16_f32 v115, v94, v95
    v_lshlrev_b32 v24, 16, v48
    v_lshlrev_b32 v88, 16, v112
    v_and_b32 v25, 0xffff0000, v48
    v_and_b32 v89, 0xffff0000, v112
    v_lshlrev_b32 v26, 16, v49
    v_lshlrev_b32 v90, 16, v113
    v_and_b32 v27, 0xffff0000, v49
    v_and_b32 v91, 0xffff0000, v113
    v_lshlrev_b32 v28, 16, v50
    v_lshlrev_b32 v92, 16, v114
    v_and_b32 v29, 0xffff0000, v50
    v_and_b32 v93, 0xffff0000, v114
    v_lshlrev_b32 v30, 16, v51
    v_lshlrev_b32 v94, 16, v115
    v_and_b32 v31, 0xffff0000, v51
    v_and_b32 v95, 0xffff0000, v115
    v_pk_add_f32 v[24:25], v[24:25], v[40:41]
    v_pk_add_f32 v[88:89], v[88:89], v[104:105]
    v_pk_add_f32 v[26:27], v[26:27], v[42:43]
    v_pk_add_f32 v[90:91], v[90:91], v[106:107]
    v_pk_add_f32 v[28:29], v[28:29], v[44:45]
    v_pk_add_f32 v[92:93], v[92:93], v[108:109]
    v_pk_add_f32 v[30:31], v[30:31], v[46:47]
    v_pk_add_f32 v[94:95], v[94:95], v[110:111]
    v_cvt_pk_bf16_f32 v60, v24, v25
    v_cvt_pk_bf16_f32 v124, v88, v89
    v_cvt_pk_bf16_f32 v61, v26, v27
    v_cvt_pk_bf16_f32 v125, v90, v91
    v_cvt_pk_bf16_f32 v62, v28, v29
    v_cvt_pk_bf16_f32 v126, v92, v93
    v_cvt_pk_bf16_f32 v63, v30, v31
    v_cvt_pk_bf16_f32 v127, v94, v95
    s_mov_b64 exec, s[6:7]
    ds_write_b128 v9, v[60:63] offset:0
    ds_write_b128 v9, v[124:127] offset:912
    buffer_store_dwordx4 v[56:59], v236, s[44:47], 0 offen offset:0 sc1
    buffer_store_dwordx4 v[120:123], v236, s[44:47], 0 offen offset:896 sc1
    s_mov_b64 exec, -1
    s_waitcnt lgkmcnt(0)
    s_barrier
    ds_read_b128 v[144:147], v12 offset:0
    ds_read_b128 v[148:151], v12 offset:512
    s_movk_i32 s92, 16384
    s_waitcnt lgkmcnt(1)
    buffer_store_dwordx4 v[144:147], v11, s[48:51], 0 offen sc1
    s_cmp_eq_u32 s32, 3
    s_cbranch_scc1 Lh2_56
    s_waitcnt lgkmcnt(0)
    buffer_store_dwordx4 v[148:151], v11, s[48:51], s92 offen sc1
Lh2_56:
    s_waitcnt vmcnt(0) lgkmcnt(0)
    s_barrier
    s_cmp_lg_u32 s32, 0
    s_cbranch_scc1 Lpub_57
    v_mov_b32 v1, 1
    s_mov_b64 exec, 1
    s_add_u32 s3, s10, 0
    v_mov_b32 v15, s3
    buffer_store_dword v1, v15, s[40:43], 0 offen sc1
    s_mov_b64 exec, -1
Lpub_57:
    s_cmp_lg_u32 s32, 0
    s_cbranch_scc1 Lpub_58
    v_mov_b32 v1, 4
    s_mov_b64 exec, 1
    s_add_u32 s3, s10, 128
    v_mov_b32 v15, s3
    buffer_store_dword v1, v15, s[40:43], 0 offen sc1
    s_mov_b64 exec, -1
Lpub_58:
L_end:
    s_endpgm
.section .rodata,"a"
.p2align 6
.amdhsa_kernel adaLN_cond__ssm_conv_h3__swiglu_ffn__prompt_kernel
  .amdhsa_next_free_vgpr 512
  .amdhsa_next_free_sgpr 102
  .amdhsa_accum_offset 256
  .amdhsa_group_segment_fixed_size 0
  .amdhsa_kernarg_size 120
  .amdhsa_user_sgpr_count 2
  .amdhsa_user_sgpr_kernarg_segment_ptr 1
  .amdhsa_system_sgpr_workgroup_id_x 1
.end_amdhsa_kernel
```
